```python
import torch

def _softmax(x, axis=-1):
    return torch.softmax(x, dim=axis)
def _gelu(x):
    return torch.nn.functional.gelu(x, approximate="tanh")
def _silu(x):
    return torch.nn.functional.silu(x)
def _sigmoid(x):
    return torch.sigmoid(x)
def _layernorm(x, axis=-1, eps=1e-5):
    m = x.mean(dim=axis, keepdim=True)
    v = x.var(dim=axis, keepdim=True, unbiased=False)
    return (x - m) / torch.sqrt(v + eps)
def _scatter_add(tgt, idx, src, axis=0):
    return tgt.clone().index_add_(axis, idx, src)
def _segment_sum(src, seg, n):
    out = torch.zeros((n,) + src.shape[1:], dtype=src.dtype)
    return out.index_add_(0, seg, src)
def _pad(x, pw):
    flat = tuple(v for pair in reversed(pw) for v in pair)
    return torch.nn.functional.pad(x, flat)

kernel_name = 'standalone__sliding_window_attn__prompt'

def setup_inputs():

    _w = (lambda a: (lambda t: t.to(torch.bfloat16) if t.is_floating_point() else t)(torch.as_tensor(a)))
    B, H, S, D = 1, 16, 2048, 256
    return {
        "q": _w((lambda *s: torch.randn(*s, dtype=torch.bfloat16) * 0.8)(B, H, S, D)),
        "k": _w((lambda *s: torch.randn(*s, dtype=torch.bfloat16) * 0.8)(B, H, S, D)),
        "v": _w((lambda *s: torch.randn(*s, dtype=torch.bfloat16) * 0.05)(B, H, S, D)),
        "window": 256,
    }

def reference(q, k, v, window):
    B, H, S, D = q.shape
    scale = D ** -0.5
    scores = torch.einsum("bhqd,bhkd->bhqk", q, k) * scale
    idx = torch.arange(S)
    mask = (idx[:, None] - idx[None, :] >= 0) & (idx[:, None] - idx[None, :] < window)
    scores = torch.where(mask[None, None], scores, -1e9)
    p = _softmax(scores, axis=-1)
    return torch.einsum("bhqk,bhkd->bhqd", p, v)
```

```asm
; @launch grid=(256,1,1) block=(256,1,1) lds=163840
.amdgcn_target "amdgcn-amd-amdhsa--gfx950"
.text
.globl standalone__sliding_window_attn__prompt_kernel
.p2align 8
.type standalone__sliding_window_attn__prompt_kernel,@function
standalone__sliding_window_attn__prompt_kernel:
    s_cmp_ge_u32 s2, 256
    s_cbranch_scc1 L_end
    s_load_dwordx4 s[64:67], s[0:1], 0
    s_load_dwordx2 s[68:69], s[0:1], 16
    s_load_dwordx2 s[70:71], s[0:1], 32
    v_lshrrev_b32 v247, 6, v0
    v_and_b32 v0, 63, v0
    v_readfirstlane_b32 s20, v247
    s_and_b32 s52, s2, 7
    s_lshr_b32 s53, s2, 3
    s_and_b32 s21, s53, 15
    s_lshr_b32 s53, s53, 4
    s_lshl_b32 s52, s52, 1
    s_add_u32 s22, s52, s53
    s_lshl_b32 s22, s22, 20
    v_lshrrev_b32 v247, 4, v0
    v_and_b32 v246, 15, v0
    v_xor_b32 v246, v246, v247
    v_lshlrev_b32 v246, 4, v246
    v_lshlrev_b32 v247, 9, v247
    v_or_b32 v246, v247, v246
    v_xor_b32 v236, 0, v246
    v_xor_b32 v237, 64, v246
    v_add_u32 v237, 0x400, v237
    v_xor_b32 v238, 0x80, v246
    v_add_u32 v238, 0x800, v238
    v_xor_b32 v239, 0xc0, v246
    v_add_u32 v239, 0xc00, v239
    v_add_u32 v240, 0x100, v236
    v_add_u32 v241, 0x100, v237
    v_add_u32 v242, 0x100, v238
    v_add_u32 v243, 0x100, v239
    v_lshrrev_b32 v244, 5, v0
    v_and_b32 v245, 31, v0
    s_lshl_b32 s53, s21, 16
    s_lshl_b32 s54, s20, 14
    s_add_u32 s40, s53, s54
    s_add_u32 s41, s40, 0x1000
    s_add_u32 s42, s40, 0x2000
    s_add_u32 s43, s40, 0x3000
    s_add_u32 s101, s54, 0x18000
    s_waitcnt lgkmcnt(0)
    s_add_u32 s4, s64, s22
    s_addc_u32 s5, s65, 0
    s_mov_b32 s6, 0x100000
    s_mov_b32 s7, 0x20000
    s_add_u32 m0, s101, 0
    s_nop 0
    buffer_load_dwordx4 v236, s[4:7], s40 offen nt lds
    s_add_u32 s8, s66, s22
    s_addc_u32 s9, s67, 0
    s_mov_b32 s10, 0x100000
    s_mov_b32 s11, 0x20000
    s_lshl_b32 s23, s20, 12
    s_lshl_b32 s39, s20, 11
    s_and_b32 s52, s20, 1
    s_lshl_b32 s52, s52, 7
    v_xor_b32 v232, s52, v236
    v_xor_b32 v233, s52, v237
    v_xor_b32 v234, s52, v240
    v_xor_b32 v235, s52, v241
    s_lshl_b32 s53, s21, 16
    s_add_u32 s56, s53, s23
    s_add_u32 s32, s56, 0
    buffer_load_dwordx4 v237, s[4:7], s40 offen offset:1024 nt lds
    s_add_u32 s28, s56, 0xffff0000
    s_cmp_ge_u32 s21, 1
    s_cselect_b32 s28, s28, 0x40000000
    s_add_u32 s24, s56, 0xfffe0000
    s_cmp_ge_u32 s21, 2
    s_cselect_b32 s24, s24, 0x40000000
    s_add_u32 s33, s56, 0x4000
    s_add_u32 s29, s56, 0xffff4000
    s_cmp_ge_u32 s21, 1
    s_cselect_b32 s29, s29, 0x40000000
    s_add_u32 s25, s56, 0xfffe4000
    s_cmp_ge_u32 s21, 2
    s_cselect_b32 s25, s25, 0x40000000
    s_add_u32 s34, s56, 0x8000
    s_add_u32 s30, s56, 0xffff8000
    buffer_load_dwordx4 v238, s[4:7], s40 offen offset:2048 nt lds
    s_cmp_ge_u32 s21, 1
    s_cselect_b32 s30, s30, 0x40000000
    s_add_u32 s26, s56, 0xfffe8000
    s_cmp_ge_u32 s21, 2
    s_cselect_b32 s26, s26, 0x40000000
    s_add_u32 s35, s56, 0xc000
    s_add_u32 s31, s56, 0xffffc000
    s_cmp_ge_u32 s21, 1
    s_cselect_b32 s31, s31, 0x40000000
    s_add_u32 s27, s56, 0xfffec000
    s_cmp_ge_u32 s21, 2
    s_cselect_b32 s27, s27, 0x40000000
    s_add_u32 s12, s68, s22
    s_addc_u32 s13, s69, 0
    s_mov_b32 s14, 0x100000
    buffer_load_dwordx4 v239, s[4:7], s40 offen offset:3072 nt lds
    s_mov_b32 s15, 0x20000
    s_add_u32 s16, s70, s22
    s_addc_u32 s17, s71, 0
    s_mov_b32 s18, 0x100000
    s_mov_b32 s19, 0x20000
    s_mov_b32 s48, 0x3db8aa3b
    s_mov_b32 s50, 0xf1800000
    s_mov_b32 s51, 0x2f800000
    s_mov_b32 s49, 0x4f800000
    s_cmp_gt_u32 s20, 0
    s_cselect_b32 s44, -1, 0
    s_cmp_gt_u32 s20, 1
    s_cselect_b32 s45, -1, 0
    s_cmp_gt_u32 s20, 2
    s_cselect_b32 s46, -1, 0
    s_add_u32 m0, s101, 0x1000
    s_nop 0
    buffer_load_dwordx4 v236, s[4:7], s42 offen nt lds
    s_lshl_b32 s52, s21, 16
    s_lshl_b32 s53, s20, 14
    s_add_u32 s52, s52, s53
    s_add_u32 s36, s52, 0xfffe0000
    s_cmp_ge_u32 s21, 2
    s_cselect_b32 s36, s36, 0x40000000
    s_add_u32 s37, s52, 0xffff0000
    s_cmp_ge_u32 s21, 1
    s_cselect_b32 s37, s37, 0x40000000
    s_add_u32 s38, s52, 0
    v_and_b32 v247, 15, v245
    v_xor_b32 v247, v247, v244
    v_lshlrev_b32 v247, 4, v247
    v_lshlrev_b32 v248, 8, v245
    v_or_b32 v247, v247, v248
    buffer_load_dwordx4 v237, s[4:7], s42 offen offset:1024 nt lds
    v_xor_b32 v160, 0, v247
    v_xor_b32 v161, 32, v247
    v_xor_b32 v162, 64, v247
    v_xor_b32 v163, 0x60, v247
    v_xor_b32 v164, 0x80, v247
    v_xor_b32 v165, 0xa0, v247
    v_xor_b32 v166, 0xc0, v247
    v_xor_b32 v167, 0xe0, v247
    v_add_u32 v168, 0x10000, v160
    v_add_u32 v169, 0x10000, v161
    v_add_u32 v170, 0x10000, v162
    v_add_u32 v171, 0x10000, v163
    v_add_u32 v172, 0x10000, v164
    v_add_u32 v173, 0x10000, v165
    v_add_u32 v174, 0x10000, v166
    buffer_load_dwordx4 v238, s[4:7], s42 offen offset:2048 nt lds
    v_add_u32 v175, 0x10000, v167
    v_add_u32 v176, 0x20000, v160
    v_add_u32 v177, 0x20000, v161
    v_add_u32 v178, 0x20000, v162
    v_add_u32 v179, 0x20000, v163
    v_add_u32 v180, 0x20000, v164
    v_add_u32 v181, 0x20000, v165
    v_add_u32 v182, 0x20000, v166
    v_add_u32 v183, 0x20000, v167
    s_and_b32 s52, s44, 0x4000
    s_add_u32 s52, s52, 0x8000
    v_add_u32 v184, s52, v160
    v_add_u32 v185, s52, v161
    v_add_u32 v186, s52, v162
    v_add_u32 v187, s52, v163
    buffer_load_dwordx4 v239, s[4:7], s42 offen offset:3072 nt lds
    v_add_u32 v188, s52, v164
    v_add_u32 v189, s52, v165
    v_add_u32 v190, s52, v166
    v_add_u32 v191, s52, v167
    s_and_b32 s52, s45, 0xffff0000
    s_add_u32 s52, s52, 0x24000
    v_add_u32 v192, s52, v160
    v_add_u32 v193, s52, v161
    v_add_u32 v194, s52, v162
    v_add_u32 v195, s52, v163
    v_add_u32 v196, s52, v164
    v_add_u32 v197, s52, v165
    v_add_u32 v198, s52, v166
    v_add_u32 v199, s52, v167
    s_and_b32 s52, s46, 0xffffc000
    s_add_u32 m0, s39, 0
    s_nop 0
    buffer_load_dwordx4 v232, s[8:11], s32 offen lds
    s_add_u32 s52, s52, 0x1c000
    s_mov_b32 s47, s52
    s_lshl_b32 s52, s20, 14
    s_add_u32 s52, s52, 0x18000
    v_add_u32 v200, s52, v160
    v_add_u32 v201, s52, v161
    v_add_u32 v202, s52, v162
    v_add_u32 v203, s52, v163
    v_add_u32 v204, s52, v164
    v_add_u32 v205, s52, v165
    v_add_u32 v206, s52, v166
    v_add_u32 v207, s52, v167
    v_lshrrev_b32 v250, 2, v0
    v_and_b32 v250, 3, v250
    v_lshrrev_b32 v251, 4, v0
    buffer_load_dwordx4 v233, s[8:11], s32 offen offset:1024 lds
    v_and_b32 v251, 1, v251
    v_and_b32 v252, 3, v0
    v_lshlrev_b32 v247, 5, v251
    v_and_b32 v248, 1, v252
    v_lshlrev_b32 v248, 4, v248
    v_or_b32 v247, v247, v248
    v_lshrrev_b32 v248, 1, v252
    v_lshlrev_b32 v248, 3, v248
    v_or_b32 v247, v247, v248
    v_lshlrev_b32 v248, 2, v244
    v_or_b32 v248, v248, v250
    v_lshlrev_b32 v249, 7, v248
    v_or_b32 v249, v249, v247
    v_lshrrev_b32 v246, 1, v250
    v_lshlrev_b32 v246, 6, v246
    s_add_u32 m0, s39, 0x4000
    s_nop 0
    buffer_load_dwordx4 v232, s[8:11], s28 offen lds
    v_or_b32 v249, v249, v246
    v_xor_b32 v208, 0, v249
    v_xor_b32 v209, 64, v249
    v_add_u32 v210, 0x10000, v208
    v_add_u32 v211, 0x10000, v209
    v_add_u32 v212, 0x20000, v208
    v_add_u32 v213, 0x20000, v209
    v_lshrrev_b32 v247, 3, v0
    v_lshlrev_b32 v247, 9, v247
    v_and_b32 v248, 7, v0
    v_lshlrev_b32 v249, 2, v251
    v_xor_b32 v248, v248, v249
    v_lshlrev_b32 v248, 4, v248
    v_or_b32 v1, v247, v248
    v_add_u32 v2, 0xc00, v1
    buffer_load_dwordx4 v233, s[8:11], s28 offen offset:1024 lds
    v_add_u32 v3, 0x1800, v1
    v_add_u32 v4, 0x2400, v1
    v_and_b32 v247, 7, v245
    v_xor_b32 v247, v247, v244
    v_lshlrev_b32 v247, 4, v247
    v_lshlrev_b32 v248, 7, v245
    v_or_b32 v247, v247, v248
    s_add_u32 s52, s23, 0x24000
    v_add_u32 v247, s52, v247
    v_xor_b32 v6, 0, v247
    v_xor_b32 v7, 32, v247
    v_xor_b32 v8, 64, v247
    v_xor_b32 v9, 0x60, v247
    v_lshrrev_b32 v247, 3, v0
    v_and_b32 v248, 7, v0
    s_add_u32 m0, s39, 0x8000
    s_nop 0
    buffer_load_dwordx4 v232, s[8:11], s24 offen nt lds
    v_xor_b32 v249, v248, v247
    v_lshlrev_b32 v249, 4, v249
    v_lshlrev_b32 v246, 7, v247
    v_or_b32 v249, v249, v246
    v_add_u32 v10, s52, v249
    v_lshlrev_b32 v247, 9, v247
    v_lshlrev_b32 v248, 4, v248
    v_or_b32 v11, v247, v248
    v_lshlrev_b32 v247, 9, v245
    v_lshlrev_b32 v248, 4, v244
    v_or_b32 v13, v247, v248
    v_lshlrev_b32 v247, 2, v244
    v_sub_u32 v247, v245, v247
    v_cmp_ge_i32 s[64:65], v247, 0
    v_cmp_ge_i32 s[66:67], v247, 1
    buffer_load_dwordx4 v233, s[8:11], s24 offen offset:1024 nt lds
    v_cmp_ge_i32 s[68:69], v247, 2
    v_cmp_ge_i32 s[70:71], v247, 3
    v_cmp_ge_i32 s[72:73], v247, 8
    v_cmp_ge_i32 s[74:75], v247, 9
    v_cmp_ge_i32 s[76:77], v247, 10
    v_cmp_ge_i32 s[78:79], v247, 11
    v_cmp_ge_i32 s[80:81], v247, 16
    v_cmp_ge_i32 s[82:83], v247, 17
    v_cmp_ge_i32 s[84:85], v247, 18
    v_cmp_ge_i32 s[86:87], v247, 19
    v_cmp_ge_i32 s[88:89], v247, 24
    v_cmp_ge_i32 s[90:91], v247, 25
    v_cmp_ge_i32 s[92:93], v247, 26
    v_cmp_ge_i32 s[94:95], v247, 27
    s_lshl_b32 s57, s21, 2
    s_add_u32 m0, s39, 0xc000
    s_nop 0
    buffer_load_dwordx4 v232, s[8:11], s33 offen lds
    s_add_u32 s56, s20, 8
    s_mov_b32 s52, 8
    s_add_u32 s53, s52, s57
    s_cmp_lt_u32 s53, 8
    s_cselect_b32 s54, s50, 0
    s_cmp_eq_u32 s52, s56
    s_cselect_b32 s53, s50, s54
    s_cmp_eq_u32 s52, s20
    s_cselect_b32 s55, s50, s54
    v_mov_b32 v253, s53
    v_mov_b32 v254, s55
    v_cndmask_b32 v16, v253, v254, s[64:65]
    v_cndmask_b32 v17, v253, v254, s[66:67]
    v_cndmask_b32 v18, v253, v254, s[68:69]
    v_cndmask_b32 v19, v253, v254, s[70:71]
    buffer_load_dwordx4 v233, s[8:11], s33 offen offset:1024 lds
    v_cndmask_b32 v20, v253, v254, s[72:73]
    v_cndmask_b32 v21, v253, v254, s[74:75]
    v_cndmask_b32 v22, v253, v254, s[76:77]
    v_cndmask_b32 v23, v253, v254, s[78:79]
    v_cndmask_b32 v24, v253, v254, s[80:81]
    v_cndmask_b32 v25, v253, v254, s[82:83]
    v_cndmask_b32 v26, v253, v254, s[84:85]
    v_cndmask_b32 v27, v253, v254, s[86:87]
    v_cndmask_b32 v28, v253, v254, s[88:89]
    v_cndmask_b32 v29, v253, v254, s[90:91]
    v_cndmask_b32 v30, v253, v254, s[92:93]
    v_cndmask_b32 v31, v253, v254, s[94:95]
    s_mov_b32 s52, 4
    s_add_u32 s53, s52, s57
    s_cmp_lt_u32 s53, 8
    s_cselect_b32 s54, s50, 0
    s_add_u32 m0, s39, 0x10000
    s_nop 0
    buffer_load_dwordx4 v232, s[8:11], s29 offen lds
    v_mov_b32 v32, s54
    v_mov_b32 v33, s54
    v_mov_b32 v34, s54
    v_mov_b32 v35, s54
    v_mov_b32 v36, s54
    v_mov_b32 v37, s54
    v_mov_b32 v38, s54
    v_mov_b32 v39, s54
    v_mov_b32 v40, s54
    v_mov_b32 v41, s54
    v_mov_b32 v42, s54
    v_mov_b32 v43, s54
    v_mov_b32 v44, s54
    v_mov_b32 v45, s54
    v_mov_b32 v46, s54
    buffer_load_dwordx4 v233, s[8:11], s29 offen offset:1024 lds
    v_mov_b32 v47, s54
    s_cmp_gt_u32 s20, 0
    s_cselect_b32 s52, 9, 0
    s_add_u32 s53, s52, s57
    s_cmp_lt_u32 s53, 8
    s_cselect_b32 s54, s50, 0
    s_cmp_eq_u32 s52, s56
    s_cselect_b32 s53, s50, s54
    s_cmp_eq_u32 s52, s20
    s_cselect_b32 s55, s50, s54
    v_mov_b32 v253, s53
    v_mov_b32 v254, s55
    v_cndmask_b32 v48, v253, v254, s[64:65]
    v_cndmask_b32 v49, v253, v254, s[66:67]
    v_cndmask_b32 v50, v253, v254, s[68:69]
    s_add_u32 m0, s101, 0x2000
    s_nop 0
    buffer_load_dwordx4 v240, s[4:7], s40 offen nt lds
    v_cndmask_b32 v51, v253, v254, s[70:71]
    v_cndmask_b32 v52, v253, v254, s[72:73]
    v_cndmask_b32 v53, v253, v254, s[74:75]
    v_cndmask_b32 v54, v253, v254, s[76:77]
    v_cndmask_b32 v55, v253, v254, s[78:79]
    v_cndmask_b32 v56, v253, v254, s[80:81]
    v_cndmask_b32 v57, v253, v254, s[82:83]
    v_cndmask_b32 v58, v253, v254, s[84:85]
    v_cndmask_b32 v59, v253, v254, s[86:87]
    v_cndmask_b32 v60, v253, v254, s[88:89]
    v_cndmask_b32 v61, v253, v254, s[90:91]
    v_cndmask_b32 v62, v253, v254, s[92:93]
    v_cndmask_b32 v63, v253, v254, s[94:95]
    s_mov_b32 s52, 5
    s_add_u32 s53, s52, s57
    buffer_load_dwordx4 v241, s[4:7], s40 offen offset:1024 nt lds
    s_cmp_lt_u32 s53, 8
    s_cselect_b32 s54, s50, 0
    v_mov_b32 v64, s54
    v_mov_b32 v65, s54
    v_mov_b32 v66, s54
    v_mov_b32 v67, s54
    v_mov_b32 v68, s54
    v_mov_b32 v69, s54
    v_mov_b32 v70, s54
    v_mov_b32 v71, s54
    v_mov_b32 v72, s54
    v_mov_b32 v73, s54
    v_mov_b32 v74, s54
    v_mov_b32 v75, s54
    v_mov_b32 v76, s54
    buffer_load_dwordx4 v242, s[4:7], s40 offen offset:2048 nt lds
    v_mov_b32 v77, s54
    v_mov_b32 v78, s54
    v_mov_b32 v79, s54
    s_cmp_gt_u32 s20, 1
    s_cselect_b32 s52, 10, 1
    s_add_u32 s53, s52, s57
    s_cmp_lt_u32 s53, 8
    s_cselect_b32 s54, s50, 0
    s_cmp_eq_u32 s52, s56
    s_cselect_b32 s53, s50, s54
    s_cmp_eq_u32 s52, s20
    s_cselect_b32 s55, s50, s54
    v_mov_b32 v253, s53
    v_mov_b32 v254, s55
    v_cndmask_b32 v80, v253, v254, s[64:65]
    buffer_load_dwordx4 v243, s[4:7], s40 offen offset:3072 nt lds
    v_cndmask_b32 v81, v253, v254, s[66:67]
    v_cndmask_b32 v82, v253, v254, s[68:69]
    v_cndmask_b32 v83, v253, v254, s[70:71]
    v_cndmask_b32 v84, v253, v254, s[72:73]
    v_cndmask_b32 v85, v253, v254, s[74:75]
    v_cndmask_b32 v86, v253, v254, s[76:77]
    v_cndmask_b32 v87, v253, v254, s[78:79]
    v_cndmask_b32 v88, v253, v254, s[80:81]
    v_cndmask_b32 v89, v253, v254, s[82:83]
    v_cndmask_b32 v90, v253, v254, s[84:85]
    v_cndmask_b32 v91, v253, v254, s[86:87]
    v_cndmask_b32 v92, v253, v254, s[88:89]
    v_cndmask_b32 v93, v253, v254, s[90:91]
    v_cndmask_b32 v94, v253, v254, s[92:93]
    v_cndmask_b32 v95, v253, v254, s[94:95]
    s_mov_b32 s52, 6
    s_add_u32 s53, s52, s57
    s_cmp_lt_u32 s53, 8
    s_cselect_b32 s54, s50, 0
    v_mov_b32 v96, s54
    v_mov_b32 v97, s54
    v_mov_b32 v98, s54
    v_mov_b32 v99, s54
    v_mov_b32 v100, s54
    v_mov_b32 v101, s54
    v_mov_b32 v102, s54
    v_mov_b32 v103, s54
    v_mov_b32 v104, s54
    v_mov_b32 v105, s54
    v_mov_b32 v106, s54
    v_mov_b32 v107, s54
    v_mov_b32 v108, s54
    v_mov_b32 v109, s54
    v_mov_b32 v110, s54
    v_mov_b32 v111, s54
    s_cmp_gt_u32 s20, 2
    s_cselect_b32 s52, 11, 2
    s_add_u32 s53, s52, s57
    s_cmp_lt_u32 s53, 8
    s_cselect_b32 s54, s50, 0
    s_cmp_eq_u32 s52, s56
    s_cselect_b32 s53, s50, s54
    s_cmp_eq_u32 s52, s20
    s_cselect_b32 s55, s50, s54
    v_mov_b32 v253, s53
    v_mov_b32 v254, s55
    v_cndmask_b32 v112, v253, v254, s[64:65]
    v_cndmask_b32 v113, v253, v254, s[66:67]
    v_cndmask_b32 v114, v253, v254, s[68:69]
    v_cndmask_b32 v115, v253, v254, s[70:71]
    v_cndmask_b32 v116, v253, v254, s[72:73]
    v_cndmask_b32 v117, v253, v254, s[74:75]
    v_cndmask_b32 v118, v253, v254, s[76:77]
    v_cndmask_b32 v119, v253, v254, s[78:79]
    v_cndmask_b32 v120, v253, v254, s[80:81]
    v_cndmask_b32 v121, v253, v254, s[82:83]
    v_cndmask_b32 v122, v253, v254, s[84:85]
    v_cndmask_b32 v123, v253, v254, s[86:87]
    v_cndmask_b32 v124, v253, v254, s[88:89]
    v_cndmask_b32 v125, v253, v254, s[90:91]
    v_cndmask_b32 v126, v253, v254, s[92:93]
    v_cndmask_b32 v127, v253, v254, s[94:95]
    s_mov_b32 s52, 7
    s_add_u32 s53, s52, s57
    s_cmp_lt_u32 s53, 8
    s_cselect_b32 s54, s50, 0
    v_mov_b32 v128, s54
    v_mov_b32 v129, s54
    v_mov_b32 v130, s54
    v_mov_b32 v131, s54
    v_mov_b32 v132, s54
    v_mov_b32 v133, s54
    v_mov_b32 v134, s54
    v_mov_b32 v135, s54
    v_mov_b32 v136, s54
    v_mov_b32 v137, s54
    v_mov_b32 v138, s54
    v_mov_b32 v139, s54
    v_mov_b32 v140, s54
    v_mov_b32 v141, s54
    v_mov_b32 v142, s54
    v_mov_b32 v143, s54
    s_mov_b32 s52, 3
    s_add_u32 s53, s52, s57
    s_cmp_lt_u32 s53, 8
    s_cselect_b32 s54, s50, 0
    s_cmp_eq_u32 s52, s56
    s_cselect_b32 s53, s50, s54
    s_cmp_eq_u32 s52, s20
    s_cselect_b32 s55, s50, s54
    v_mov_b32 v253, s53
    v_mov_b32 v254, s55
    v_cndmask_b32 v144, v253, v254, s[64:65]
    v_cndmask_b32 v145, v253, v254, s[66:67]
    v_cndmask_b32 v146, v253, v254, s[68:69]
    v_cndmask_b32 v147, v253, v254, s[70:71]
    v_cndmask_b32 v148, v253, v254, s[72:73]
    v_cndmask_b32 v149, v253, v254, s[74:75]
    v_cndmask_b32 v150, v253, v254, s[76:77]
    v_cndmask_b32 v151, v253, v254, s[78:79]
    v_cndmask_b32 v152, v253, v254, s[80:81]
    v_cndmask_b32 v153, v253, v254, s[82:83]
    v_cndmask_b32 v154, v253, v254, s[84:85]
    v_cndmask_b32 v155, v253, v254, s[86:87]
    v_cndmask_b32 v156, v253, v254, s[88:89]
    v_cndmask_b32 v157, v253, v254, s[90:91]
    v_cndmask_b32 v158, v253, v254, s[92:93]
    v_cndmask_b32 v159, v253, v254, s[94:95]
    v_mov_b32 v5, 0
    s_waitcnt vmcnt(14)
    ds_read_b128 a[0:3], v200
    ds_read_b128 a[4:7], v201
    ds_read_b128 a[8:11], v202
    ds_read_b128 a[12:15], v203
    ds_read_b128 a[16:19], v204
    ds_read_b128 a[20:23], v205
    ds_read_b128 a[24:27], v206
    ds_read_b128 a[28:31], v207
    s_waitcnt vmcnt(12)
    s_barrier
    ds_read_b128 a[64:67], v160
    ds_read_b128 a[68:71], v161
    ds_read_b128 a[72:75], v162
    ds_read_b128 a[76:79], v163
    ds_read_b128 a[80:83], v164
    ds_read_b128 a[84:87], v165
    s_waitcnt lgkmcnt(5)
    v_mfma_f32_32x32x16_bf16 v[16:31], a[64:67], a[0:3], v[16:31]
    s_waitcnt lgkmcnt(4)
    s_add_u32 m0, s101, 0x3000
    ds_read_b128 a[88:91], v166
    buffer_load_dwordx4 v240, s[4:7], s42 offen nt lds
    v_mfma_f32_32x32x16_bf16 v[16:31], a[68:71], a[4:7], v[16:31]
    s_waitcnt lgkmcnt(4)
    s_waitcnt vmcnt(11)
    s_barrier
    ds_read_b128 a[92:95], v167
    buffer_load_dwordx4 v241, s[4:7], s42 offen offset:1024 nt lds
    v_mfma_f32_32x32x16_bf16 v[16:31], a[72:75], a[8:11], v[16:31]
    s_waitcnt lgkmcnt(4)
    ds_read_b128 a[64:67], v160 offset:16384
    buffer_load_dwordx4 v242, s[4:7], s42 offen offset:2048 nt lds
    v_mfma_f32_32x32x16_bf16 v[16:31], a[76:79], a[12:15], v[16:31]
    s_waitcnt lgkmcnt(4)
    ds_read_b128 a[68:71], v161 offset:16384
    buffer_load_dwordx4 v243, s[4:7], s42 offen offset:3072 nt lds
    v_mfma_f32_32x32x16_bf16 v[16:31], a[80:83], a[16:19], v[16:31]
    s_waitcnt lgkmcnt(4)
    s_add_u32 m0, s39, 0x2000
    ds_read_b128 a[72:75], v162 offset:16384
    buffer_load_dwordx4 v234, s[8:11], s32 offen lds
    v_mfma_f32_32x32x16_bf16 v[16:31], a[84:87], a[20:23], v[16:31]
    s_waitcnt lgkmcnt(4)
    ds_read_b128 a[76:79], v163 offset:16384
    buffer_load_dwordx4 v235, s[8:11], s32 offen offset:1024 lds
    v_mfma_f32_32x32x16_bf16 v[16:31], a[88:91], a[24:27], v[16:31]
    s_waitcnt lgkmcnt(4)
    s_add_u32 m0, s39, 0x6000
    ds_read_b128 a[80:83], v164 offset:16384
    buffer_load_dwordx4 v234, s[8:11], s28 offen lds
    v_mfma_f32_32x32x16_bf16 v[16:31], a[92:95], a[28:31], v[16:31]
    s_waitcnt lgkmcnt(4)
    ds_read_b128 a[84:87], v165 offset:16384
    buffer_load_dwordx4 v235, s[8:11], s28 offen offset:1024 lds
    v_mfma_f32_32x32x16_bf16 v[32:47], a[64:67], a[0:3], v[32:47]
    s_waitcnt lgkmcnt(4)
    s_add_u32 m0, s39, 0xa000
    ds_read_b128 a[88:91], v166 offset:16384
    buffer_load_dwordx4 v234, s[8:11], s24 offen nt lds
    v_mfma_f32_32x32x16_bf16 v[32:47], a[68:71], a[4:7], v[32:47]
    s_waitcnt lgkmcnt(4)
    s_waitcnt vmcnt(15)
    s_barrier
    ds_read_b128 a[92:95], v167 offset:16384
    buffer_load_dwordx4 v235, s[8:11], s24 offen offset:1024 nt lds
    v_mfma_f32_32x32x16_bf16 v[32:47], a[72:75], a[8:11], v[32:47]
    s_waitcnt lgkmcnt(4)
    s_add_u32 m0, s39, 0xe000
    ds_read_b128 a[64:67], v184
    buffer_load_dwordx4 v234, s[8:11], s33 offen lds
    v_mfma_f32_32x32x16_bf16 v[32:47], a[76:79], a[12:15], v[32:47]
    s_waitcnt lgkmcnt(4)
    ds_read_b128 a[68:71], v185
    buffer_load_dwordx4 v235, s[8:11], s33 offen offset:1024 lds
    v_mfma_f32_32x32x16_bf16 v[32:47], a[80:83], a[16:19], v[32:47]
    s_waitcnt lgkmcnt(4)
    s_add_u32 m0, s39, 0x12000
    ds_read_b128 a[72:75], v186
    buffer_load_dwordx4 v234, s[8:11], s29 offen lds
    v_mfma_f32_32x32x16_bf16 v[32:47], a[84:87], a[20:23], v[32:47]
    s_waitcnt lgkmcnt(4)
    ds_read_b128 a[76:79], v187
    buffer_load_dwordx4 v235, s[8:11], s29 offen offset:1024 lds
    v_mfma_f32_32x32x16_bf16 v[32:47], a[88:91], a[24:27], v[32:47]
    s_waitcnt lgkmcnt(4)
    s_add_u32 m0, s39, 0x14000
    ds_read_b128 a[80:83], v188
    buffer_load_dwordx4 v232, s[8:11], s34 offen lds
    v_mfma_f32_32x32x16_bf16 v[32:47], a[92:95], a[28:31], v[32:47]
    s_waitcnt lgkmcnt(4)
    ds_read_b128 a[84:87], v189
    buffer_load_dwordx4 v233, s[8:11], s34 offen offset:1024 lds
    v_mfma_f32_32x32x16_bf16 v[48:63], a[64:67], a[0:3], v[48:63]
    s_waitcnt lgkmcnt(4)
    s_add_u32 m0, s39, 0x16000
    ds_read_b128 a[88:91], v190
    buffer_load_dwordx4 v234, s[8:11], s34 offen lds
    v_mfma_f32_32x32x16_bf16 v[48:63], a[68:71], a[4:7], v[48:63]
    s_waitcnt lgkmcnt(4)
    s_waitcnt vmcnt(21)
    s_barrier
    ds_read_b128 a[92:95], v191
    buffer_load_dwordx4 v235, s[8:11], s34 offen offset:1024 lds
    v_mfma_f32_32x32x16_bf16 v[48:63], a[72:75], a[8:11], v[48:63]
    s_waitcnt lgkmcnt(4)
    ds_read_b128 a[64:67], v168
    v_mfma_f32_32x32x16_bf16 v[48:63], a[76:79], a[12:15], v[48:63]
    s_waitcnt lgkmcnt(4)
    ds_read_b128 a[68:71], v169
    v_mfma_f32_32x32x16_bf16 v[48:63], a[80:83], a[16:19], v[48:63]
    s_waitcnt lgkmcnt(4)
    ds_read_b128 a[72:75], v170
    v_mfma_f32_32x32x16_bf16 v[48:63], a[84:87], a[20:23], v[48:63]
    s_waitcnt lgkmcnt(4)
    ds_read_b128 a[76:79], v171
    v_mfma_f32_32x32x16_bf16 v[48:63], a[88:91], a[24:27], v[48:63]
    s_waitcnt lgkmcnt(4)
    ds_read_b128 a[80:83], v172
    v_mfma_f32_32x32x16_bf16 v[48:63], a[92:95], a[28:31], v[48:63]
    s_waitcnt lgkmcnt(4)
    ds_read_b128 a[84:87], v173
    v_mfma_f32_32x32x16_bf16 v[64:79], a[64:67], a[0:3], v[64:79]
    s_waitcnt lgkmcnt(4)
    ds_read_b128 a[88:91], v174
    v_mfma_f32_32x32x16_bf16 v[64:79], a[68:71], a[4:7], v[64:79]
    s_waitcnt lgkmcnt(4)
    s_waitcnt vmcnt(12)
    s_barrier
    ds_read_b128 a[92:95], v175
    v_mfma_f32_32x32x16_bf16 v[64:79], a[72:75], a[8:11], v[64:79]
    s_waitcnt lgkmcnt(4)
    ds_read_b128 a[32:35], v200 offset:8192
    ds_read_b128 a[64:67], v160 offset:8192
    v_mfma_f32_32x32x16_bf16 v[64:79], a[76:79], a[12:15], v[64:79]
    s_waitcnt lgkmcnt(5)
    ds_read_b128 a[36:39], v201 offset:8192
    ds_read_b128 a[68:71], v161 offset:8192
    v_mfma_f32_32x32x16_bf16 v[64:79], a[80:83], a[16:19], v[64:79]
    s_waitcnt lgkmcnt(6)
    ds_read_b128 a[40:43], v202 offset:8192
    ds_read_b128 a[72:75], v162 offset:8192
    v_mfma_f32_32x32x16_bf16 v[64:79], a[84:87], a[20:23], v[64:79]
    s_waitcnt lgkmcnt(7)
    ds_read_b128 a[44:47], v203 offset:8192
    ds_read_b128 a[76:79], v163 offset:8192
    v_mfma_f32_32x32x16_bf16 v[64:79], a[88:91], a[24:27], v[64:79]
    s_waitcnt lgkmcnt(8)
    ds_read_b128 a[48:51], v204 offset:8192
    ds_read_b128 a[80:83], v164 offset:8192
    v_mfma_f32_32x32x16_bf16 v[64:79], a[92:95], a[28:31], v[64:79]
    s_waitcnt lgkmcnt(8)
    ds_read_b128 a[52:55], v205 offset:8192
    ds_read_b128 a[84:87], v165 offset:8192
    v_mfma_f32_32x32x16_bf16 v[16:31], a[64:67], a[32:35], v[16:31]
    s_waitcnt lgkmcnt(8)
    ds_read_b128 a[56:59], v206 offset:8192
    ds_read_b128 a[88:91], v166 offset:8192
    v_mfma_f32_32x32x16_bf16 v[16:31], a[68:71], a[36:39], v[16:31]
    s_waitcnt lgkmcnt(8)
    s_waitcnt vmcnt(10)
    s_barrier
    ds_read_b128 a[60:63], v207 offset:8192
    ds_read_b128 a[92:95], v167 offset:8192
    v_mfma_f32_32x32x16_bf16 v[16:31], a[72:75], a[40:43], v[16:31]
    s_waitcnt lgkmcnt(8)
    ds_read_b128 a[64:67], v160 offset:24576
    v_add_u32 v200, s47, v160
    v_add_u32 v201, s47, v161
    v_add_u32 v202, s47, v162
    v_add_u32 v203, s47, v163
    v_add_u32 v204, s47, v164
    v_add_u32 v205, s47, v165
    v_mfma_f32_32x32x16_bf16 v[16:31], a[76:79], a[44:47], v[16:31]
    s_waitcnt lgkmcnt(7)
    ds_read_b128 a[68:71], v161 offset:24576
    v_add_u32 v206, s47, v166
    v_add_u32 v207, s47, v167
    v_mfma_f32_32x32x16_bf16 v[16:31], a[80:83], a[48:51], v[16:31]
    s_waitcnt lgkmcnt(6)
    ds_read_b128 a[72:75], v162 offset:24576
    v_mfma_f32_32x32x16_bf16 v[16:31], a[84:87], a[52:55], v[16:31]
    s_waitcnt lgkmcnt(5)
    ds_read_b128 a[76:79], v163 offset:24576
    v_mfma_f32_32x32x16_bf16 v[16:31], a[88:91], a[56:59], v[16:31]
    s_waitcnt lgkmcnt(4)
    ds_read_b128 a[80:83], v164 offset:24576
    v_mfma_f32_32x32x16_bf16 v[16:31], a[92:95], a[60:63], v[16:31]
    s_waitcnt lgkmcnt(4)
    ds_read_b128 a[84:87], v165 offset:24576
    v_mfma_f32_32x32x16_bf16 v[32:47], a[64:67], a[32:35], v[32:47]
    s_waitcnt lgkmcnt(4)
    ds_read_b128 a[88:91], v166 offset:24576
    v_mfma_f32_32x32x16_bf16 v[32:47], a[68:71], a[36:39], v[32:47]
    s_waitcnt lgkmcnt(4)
    s_waitcnt vmcnt(6)
    s_barrier
    s_add_u32 m0, s39, 0x24000
    ds_read_b128 a[92:95], v167 offset:24576
    buffer_load_dwordx4 v232, s[8:11], s25 offen nt lds
    v_mul_f32 v16, s48, v16
    v_mfma_f32_32x32x16_bf16 v[32:47], a[72:75], a[40:43], v[32:47]
    s_waitcnt lgkmcnt(4)
    ds_read_b128 a[64:67], v184 offset:8192
    buffer_load_dwordx4 v233, s[8:11], s25 offen offset:1024 nt lds
    v_mul_f32 v17, s48, v17
    v_exp_f32 v16, v16
    v_mul_f32 v18, s48, v18
    v_mfma_f32_32x32x16_bf16 v[32:47], a[76:79], a[44:47], v[32:47]
    s_waitcnt lgkmcnt(4)
    s_add_u32 m0, s39, 0x26000
    ds_read_b128 a[68:71], v185 offset:8192
    buffer_load_dwordx4 v234, s[8:11], s25 offen nt lds
    v_exp_f32 v17, v17
    v_mul_f32 v19, s48, v19
    v_mfma_f32_32x32x16_bf16 v[32:47], a[80:83], a[48:51], v[32:47]
    s_waitcnt lgkmcnt(4)
    ds_read_b128 a[72:75], v186 offset:8192
    buffer_load_dwordx4 v235, s[8:11], s25 offen offset:1024 nt lds
    v_exp_f32 v18, v18
    v_add_f32 v5, v5, v16
    v_mul_f32 v20, s48, v20
    v_mfma_f32_32x32x16_bf16 v[32:47], a[84:87], a[52:55], v[32:47]
    s_waitcnt lgkmcnt(4)
    s_add_u32 m0, s39, 0
    ds_read_b128 a[76:79], v187 offset:8192
    buffer_load_dwordx4 v232, s[8:11], s30 offen lds
    v_exp_f32 v19, v19
    v_add_f32 v5, v5, v17
    v_mfma_f32_32x32x16_bf16 v[32:47], a[88:91], a[56:59], v[32:47]
    s_waitcnt lgkmcnt(4)
    ds_read_b128 a[80:83], v188 offset:8192
    buffer_load_dwordx4 v233, s[8:11], s30 offen offset:1024 lds
    v_mul_f32 v21, s48, v21
    v_exp_f32 v20, v20
    v_add_f32 v5, v5, v18
    v_mfma_f32_32x32x16_bf16 v[32:47], a[92:95], a[60:63], v[32:47]
    s_waitcnt lgkmcnt(4)
    s_add_u32 m0, s39, 0x2000
    ds_read_b128 a[84:87], v189 offset:8192
    buffer_load_dwordx4 v234, s[8:11], s30 offen lds
    v_cvt_pk_bf16_f32 v16, v16, v17
    v_mul_f32 v22, s48, v22
    v_exp_f32 v21, v21
    v_mfma_f32_32x32x16_bf16 v[48:63], a[64:67], a[32:35], v[48:63]
    s_waitcnt lgkmcnt(4)
    ds_read_b128 a[88:91], v190 offset:8192
    buffer_load_dwordx4 v235, s[8:11], s30 offen offset:1024 lds
    v_add_f32 v5, v5, v19
    v_mul_f32 v23, s48, v23
    v_exp_f32 v22, v22
    v_mfma_f32_32x32x16_bf16 v[48:63], a[68:71], a[36:39], v[48:63]
    s_waitcnt lgkmcnt(4)
    s_waitcnt vmcnt(12)
    s_barrier
    s_add_u32 m0, s39, 0x18000
    ds_read_b128 a[92:95], v191 offset:8192
    buffer_load_dwordx4 v232, s[8:11], s35 offen lds
    v_add_f32 v5, v5, v20
    v_mfma_f32_32x32x16_bf16 v[48:63], a[72:75], a[40:43], v[48:63]
    s_waitcnt lgkmcnt(4)
    ds_read_b128 a[64:67], v168 offset:8192
    buffer_load_dwordx4 v233, s[8:11], s35 offen offset:1024 lds
    v_cvt_pk_bf16_f32 v17, v18, v19
    v_mul_f32 v24, s48, v24
    v_exp_f32 v23, v23
    v_mfma_f32_32x32x16_bf16 v[48:63], a[76:79], a[44:47], v[48:63]
    s_waitcnt lgkmcnt(4)
    s_add_u32 m0, s39, 0x1a000
    ds_read_b128 a[68:71], v169 offset:8192
    buffer_load_dwordx4 v234, s[8:11], s35 offen lds
    v_add_f32 v5, v5, v21
    v_mul_f32 v25, s48, v25
    v_exp_f32 v24, v24
    v_mfma_f32_32x32x16_bf16 v[48:63], a[80:83], a[48:51], v[48:63]
    s_waitcnt lgkmcnt(4)
    ds_read_b128 a[72:75], v170 offset:8192
    buffer_load_dwordx4 v235, s[8:11], s35 offen offset:1024 lds
    v_add_f32 v5, v5, v22
    v_cvt_pk_bf16_f32 v18, v20, v21
    v_mul_f32 v26, s48, v26
    v_exp_f32 v25, v25
    v_mfma_f32_32x32x16_bf16 v[48:63], a[84:87], a[52:55], v[48:63]
    s_waitcnt lgkmcnt(4)
    s_add_u32 m0, s39, 0x1c000
    ds_read_b128 a[76:79], v171 offset:8192
    buffer_load_dwordx4 v232, s[8:11], s26 offen nt lds
    v_add_f32 v5, v5, v23
    v_mul_f32 v27, s48, v27
    v_exp_f32 v26, v26
    v_mfma_f32_32x32x16_bf16 v[48:63], a[88:91], a[56:59], v[48:63]
    s_waitcnt lgkmcnt(4)
    ds_read_b128 a[80:83], v172 offset:8192
    buffer_load_dwordx4 v233, s[8:11], s26 offen offset:1024 nt lds
    v_add_f32 v5, v5, v24
    v_cvt_pk_bf16_f32 v19, v22, v23
    v_mul_f32 v28, s48, v28
    v_exp_f32 v27, v27
    v_mfma_f32_32x32x16_bf16 v[48:63], a[92:95], a[60:63], v[48:63]
    s_waitcnt lgkmcnt(4)
    s_add_u32 m0, s39, 0x1e000
    ds_read_b128 a[84:87], v173 offset:8192
    buffer_load_dwordx4 v234, s[8:11], s26 offen nt lds
    v_add_f32 v5, v5, v25
    v_mul_f32 v29, s48, v29
    v_exp_f32 v28, v28
    v_mfma_f32_32x32x16_bf16 v[64:79], a[64:67], a[32:35], v[64:79]
    s_waitcnt lgkmcnt(4)
    ds_read_b128 a[88:91], v174 offset:8192
    buffer_load_dwordx4 v235, s[8:11], s26 offen offset:1024 nt lds
    v_add_f32 v5, v5, v26
    v_cvt_pk_bf16_f32 v20, v24, v25
    v_mul_f32 v30, s48, v30
    v_exp_f32 v29, v29
    v_mfma_f32_32x32x16_bf16 v[64:79], a[68:71], a[36:39], v[64:79]
    s_waitcnt lgkmcnt(4)
    s_waitcnt vmcnt(12)
    s_barrier
    s_add_u32 m0, s39, 0x20000
    ds_read_b128 a[92:95], v175 offset:8192
    buffer_load_dwordx4 v232, s[8:11], s31 offen lds
    v_add_f32 v5, v5, v27
    v_mfma_f32_32x32x16_bf16 v[64:79], a[72:75], a[40:43], v[64:79]
    s_waitcnt lgkmcnt(4)
    ds_read_b128 a[64:67], v192
    buffer_load_dwordx4 v233, s[8:11], s31 offen offset:1024 lds
    v_mul_f32 v31, s48, v31
    v_exp_f32 v30, v30
    v_add_f32 v5, v5, v28
    v_mfma_f32_32x32x16_bf16 v[64:79], a[76:79], a[44:47], v[64:79]
    s_waitcnt lgkmcnt(4)
    s_add_u32 m0, s39, 0x22000
    ds_read_b128 a[68:71], v193
    buffer_load_dwordx4 v234, s[8:11], s31 offen lds
    v_cvt_pk_bf16_f32 v21, v26, v27
    v_exp_f32 v31, v31
    v_mfma_f32_32x32x16_bf16 v[64:79], a[80:83], a[48:51], v[64:79]
    s_waitcnt lgkmcnt(4)
    ds_read_b128 a[72:75], v194
    buffer_load_dwordx4 v235, s[8:11], s31 offen offset:1024 lds
    v_add_f32 v5, v5, v29
    v_add_f32 v5, v5, v30
    v_cvt_pk_bf16_f32 v22, v28, v29
    v_add_f32 v5, v5, v31
    v_mfma_f32_32x32x16_bf16 v[64:79], a[84:87], a[52:55], v[64:79]
    s_waitcnt lgkmcnt(4)
    s_add_u32 m0, s39, 0x4000
    ds_read_b128 a[76:79], v195
    buffer_load_dwordx4 v232, s[8:11], s27 offen nt lds
    v_cvt_pk_bf16_f32 v23, v30, v31
    v_mul_f32 v32, s48, v32
    v_mul_f32 v33, s48, v33
    v_mfma_f32_32x32x16_bf16 v[64:79], a[88:91], a[56:59], v[64:79]
    s_waitcnt lgkmcnt(4)
    ds_read_b128 a[80:83], v196
    buffer_load_dwordx4 v233, s[8:11], s27 offen offset:1024 nt lds
    v_exp_f32 v32, v32
    v_mul_f32 v34, s48, v34
    v_exp_f32 v33, v33
    v_mfma_f32_32x32x16_bf16 v[64:79], a[92:95], a[60:63], v[64:79]
    s_waitcnt lgkmcnt(4)
    s_add_u32 m0, s39, 0x6000
    ds_read_b128 a[84:87], v197
    buffer_load_dwordx4 v234, s[8:11], s27 offen nt lds
    v_mul_f32 v35, s48, v35
    v_exp_f32 v34, v34
    v_mfma_f32_32x32x16_bf16 v[80:95], a[64:67], a[0:3], v[80:95]
    s_waitcnt lgkmcnt(4)
    ds_read_b128 a[88:91], v198
    v_add_f32 v5, v5, v32
    v_mul_f32 v36, s48, v36
    v_exp_f32 v35, v35
    v_add_f32 v5, v5, v33
    v_mul_f32 v37, s48, v37
    v_mfma_f32_32x32x16_bf16 v[80:95], a[68:71], a[4:7], v[80:95]
    s_waitcnt lgkmcnt(4)
    ds_read_b128 a[92:95], v199
    buffer_load_dwordx4 v235, s[8:11], s27 offen offset:1024 nt lds
    v_exp_f32 v36, v36
    v_add_f32 v5, v5, v34
    v_cvt_pk_bf16_f32 v24, v32, v33
    v_mfma_f32_32x32x16_bf16 v[80:95], a[72:75], a[8:11], v[80:95]
    s_waitcnt lgkmcnt(4)
    ds_read_b128 a[64:67], v192 offset:8192
    v_mul_f32 v38, s48, v38
    v_exp_f32 v37, v37
    v_add_f32 v5, v5, v35
    v_mul_f32 v39, s48, v39
    v_exp_f32 v38, v38
    v_mfma_f32_32x32x16_bf16 v[80:95], a[76:79], a[12:15], v[80:95]
    s_waitcnt lgkmcnt(4)
    s_add_u32 m0, s23, 0x8000
    ds_read_b128 a[68:71], v193 offset:8192
    buffer_load_dwordx4 v1, s[12:15], s38 offen lds
    v_add_f32 v5, v5, v36
    v_cvt_pk_bf16_f32 v25, v34, v35
    v_mul_f32 v40, s48, v40
    v_mfma_f32_32x32x16_bf16 v[80:95], a[80:83], a[16:19], v[80:95]
    s_waitcnt lgkmcnt(4)
    ds_read_b128 a[72:75], v194 offset:8192
    v_exp_f32 v39, v39
    v_add_f32 v5, v5, v37
    v_mul_f32 v41, s48, v41
    v_exp_f32 v40, v40
    v_mfma_f32_32x32x16_bf16 v[80:95], a[84:87], a[20:23], v[80:95]
    s_waitcnt lgkmcnt(4)
    ds_read_b128 a[76:79], v195 offset:8192
    buffer_load_dwordx4 v2, s[12:15], s38 offen offset:1024 lds
    v_add_f32 v5, v5, v38
    v_cvt_pk_bf16_f32 v26, v36, v37
    v_mul_f32 v42, s48, v42
    v_exp_f32 v41, v41
    v_mfma_f32_32x32x16_bf16 v[80:95], a[88:91], a[24:27], v[80:95]
    s_waitcnt lgkmcnt(4)
    ds_read_b128 a[80:83], v196 offset:8192
    v_add_f32 v5, v5, v39
    v_mul_f32 v43, s48, v43
    v_exp_f32 v42, v42
    v_add_f32 v5, v5, v40
    v_cvt_pk_bf16_f32 v27, v38, v39
    v_mfma_f32_32x32x16_bf16 v[80:95], a[92:95], a[28:31], v[80:95]
    s_waitcnt lgkmcnt(4)
    ds_read_b128 a[84:87], v197 offset:8192
    buffer_load_dwordx4 v3, s[12:15], s38 offen offset:2048 lds
    v_mul_f32 v44, s48, v44
    v_exp_f32 v43, v43
    v_add_f32 v5, v5, v41
    v_mfma_f32_32x32x16_bf16 v[80:95], a[64:67], a[32:35], v[80:95]
    s_waitcnt lgkmcnt(4)
    ds_read_b128 a[88:91], v198 offset:8192
    v_mul_f32 v45, s48, v45
    v_exp_f32 v44, v44
    v_add_f32 v5, v5, v42
    v_cvt_pk_bf16_f32 v28, v40, v41
    v_mul_f32 v46, s48, v46
    v_mfma_f32_32x32x16_bf16 v[80:95], a[68:71], a[36:39], v[80:95]
    s_waitcnt lgkmcnt(4)
    s_waitcnt vmcnt(19)
    s_barrier
    ds_read_b128 a[92:95], v199 offset:8192
    buffer_load_dwordx4 v4, s[12:15], s38 offen offset:3072 lds
    s_add_u32 s38, s38, 0x80
    v_exp_f32 v45, v45
    v_mfma_f32_32x32x16_bf16 v[80:95], a[72:75], a[40:43], v[80:95]
    s_waitcnt lgkmcnt(4)
    ds_read_b128 a[64:67], v160
    v_add_f32 v5, v5, v43
    v_mul_f32 v47, s48, v47
    v_exp_f32 v46, v46
    v_add_f32 v5, v5, v44
    v_cvt_pk_bf16_f32 v29, v42, v43
    v_mfma_f32_32x32x16_bf16 v[80:95], a[76:79], a[44:47], v[80:95]
    s_waitcnt lgkmcnt(4)
    s_add_u32 m0, s23, 0xc000
    ds_read_b128 a[68:71], v161
    buffer_load_dwordx4 v1, s[12:15], s36 offen nt lds
    v_exp_f32 v47, v47
    v_add_f32 v5, v5, v45
    v_mfma_f32_32x32x16_bf16 v[80:95], a[80:83], a[48:51], v[80:95]
    s_waitcnt lgkmcnt(4)
    ds_read_b128 a[72:75], v162
    v_add_f32 v5, v5, v46
    v_cvt_pk_bf16_f32 v30, v44, v45
    v_add_f32 v5, v5, v47
    v_cvt_pk_bf16_f32 v31, v46, v47
    v_mul_f32 v48, s48, v48
    v_mul_f32 v49, s48, v49
    v_mfma_f32_32x32x16_bf16 v[80:95], a[84:87], a[52:55], v[80:95]
    s_waitcnt lgkmcnt(4)
    ds_read_b128 a[76:79], v163
    buffer_load_dwordx4 v2, s[12:15], s36 offen offset:1024 nt lds
    v_exp_f32 v48, v48
    v_mul_f32 v50, s48, v50
    v_exp_f32 v49, v49
    v_mfma_f32_32x32x16_bf16 v[80:95], a[88:91], a[56:59], v[80:95]
    s_waitcnt lgkmcnt(4)
    ds_read_b128 a[80:83], v164
    v_mul_f32 v51, s48, v51
    v_exp_f32 v50, v50
    v_add_f32 v5, v5, v48
    v_mul_f32 v52, s48, v52
    v_exp_f32 v51, v51
    v_mfma_f32_32x32x16_bf16 v[80:95], a[92:95], a[60:63], v[80:95]
    s_waitcnt lgkmcnt(4)
    ds_read_b128 a[84:87], v165
    buffer_load_dwordx4 v3, s[12:15], s36 offen offset:2048 nt lds
    v_add_f32 v5, v5, v49
    v_mul_f32 v53, s48, v53
    v_exp_f32 v52, v52
    v_mfma_f32_32x32x16_bf16 v[96:111], a[64:67], a[0:3], v[96:111]
    s_waitcnt lgkmcnt(4)
    ds_read_b128 a[88:91], v166
    v_add_f32 v5, v5, v50
    v_cvt_pk_bf16_f32 v32, v48, v49
    v_mul_f32 v54, s48, v54
    v_exp_f32 v53, v53
    v_add_f32 v5, v5, v51
    v_mfma_f32_32x32x16_bf16 v[96:111], a[68:71], a[4:7], v[96:111]
    s_waitcnt lgkmcnt(4)
    ds_read_b128 a[92:95], v167
    buffer_load_dwordx4 v4, s[12:15], s36 offen offset:3072 nt lds
    s_add_u32 s36, s36, 0x80
    v_mul_f32 v55, s48, v55
    v_exp_f32 v54, v54
    v_mfma_f32_32x32x16_bf16 v[96:111], a[72:75], a[8:11], v[96:111]
    s_waitcnt lgkmcnt(4)
    ds_read_b128 a[64:67], v160 offset:8192
    v_add_f32 v5, v5, v52
    v_cvt_pk_bf16_f32 v33, v50, v51
    v_mul_f32 v56, s48, v56
    v_exp_f32 v55, v55
    v_add_f32 v5, v5, v53
    v_mfma_f32_32x32x16_bf16 v[96:111], a[76:79], a[12:15], v[96:111]
    s_waitcnt lgkmcnt(4)
    s_add_u32 m0, s23, 0x10000
    ds_read_b128 a[68:71], v161 offset:8192
    buffer_load_dwordx4 v1, s[12:15], s37 offen lds
    v_mul_f32 v57, s48, v57
    v_exp_f32 v56, v56
    v_mfma_f32_32x32x16_bf16 v[96:111], a[80:83], a[16:19], v[96:111]
    s_waitcnt lgkmcnt(4)
    ds_read_b128 a[72:75], v162 offset:8192
    v_add_f32 v5, v5, v54
    v_cvt_pk_bf16_f32 v34, v52, v53
    v_mul_f32 v58, s48, v58
    v_exp_f32 v57, v57
    v_add_f32 v5, v5, v55
    v_mfma_f32_32x32x16_bf16 v[96:111], a[84:87], a[20:23], v[96:111]
    s_waitcnt lgkmcnt(4)
    ds_read_b128 a[76:79], v163 offset:8192
    buffer_load_dwordx4 v2, s[12:15], s37 offen offset:1024 lds
    v_mul_f32 v59, s48, v59
    v_exp_f32 v58, v58
    v_add_f32 v5, v5, v56
    v_mfma_f32_32x32x16_bf16 v[96:111], a[88:91], a[24:27], v[96:111]
    s_waitcnt lgkmcnt(4)
    ds_read_b128 a[80:83], v164 offset:8192
    v_cvt_pk_bf16_f32 v35, v54, v55
    v_mul_f32 v60, s48, v60
    v_exp_f32 v59, v59
    v_add_f32 v5, v5, v57
    v_mul_f32 v61, s48, v61
    v_mfma_f32_32x32x16_bf16 v[96:111], a[92:95], a[28:31], v[96:111]
    s_waitcnt lgkmcnt(4)
    ds_read_b128 a[84:87], v165 offset:8192
    buffer_load_dwordx4 v3, s[12:15], s37 offen offset:2048 lds
    v_exp_f32 v60, v60
    v_add_f32 v5, v5, v58
    v_cvt_pk_bf16_f32 v36, v56, v57
    v_mfma_f32_32x32x16_bf16 v[96:111], a[64:67], a[32:35], v[96:111]
    s_waitcnt lgkmcnt(4)
    ds_read_b128 a[88:91], v166 offset:8192
    v_mul_f32 v62, s48, v62
    v_exp_f32 v61, v61
    v_add_f32 v5, v5, v59
    v_mul_f32 v63, s48, v63
    v_exp_f32 v62, v62
    v_mfma_f32_32x32x16_bf16 v[96:111], a[68:71], a[36:39], v[96:111]
    s_waitcnt lgkmcnt(4)
    s_waitcnt vmcnt(19)
    s_barrier
    ds_read_b128 a[92:95], v167 offset:8192
    buffer_load_dwordx4 v4, s[12:15], s37 offen offset:3072 lds
    s_add_u32 s37, s37, 0x80
    v_add_f32 v5, v5, v60
    v_mfma_f32_32x32x16_bf16 v[96:111], a[72:75], a[40:43], v[96:111]
    s_waitcnt lgkmcnt(4)
    ds_read_b128 a[64:67], v200
    v_cvt_pk_bf16_f32 v37, v58, v59
    v_exp_f32 v63, v63
    v_add_f32 v5, v5, v61
    v_add_f32 v5, v5, v62
    v_cvt_pk_bf16_f32 v38, v60, v61
    v_mfma_f32_32x32x16_bf16 v[96:111], a[76:79], a[44:47], v[96:111]
    s_waitcnt lgkmcnt(4)
    s_add_u32 m0, s23, 0x14000
    ds_read_b128 a[68:71], v201
    buffer_load_dwordx4 v1, s[12:15], s38 offen lds
    v_add_f32 v5, v5, v63
    v_cvt_pk_bf16_f32 v39, v62, v63
    v_mul_f32 v64, s48, v64
    v_mfma_f32_32x32x16_bf16 v[96:111], a[80:83], a[48:51], v[96:111]
    s_waitcnt lgkmcnt(4)
    ds_read_b128 a[72:75], v202
    v_mul_f32 v65, s48, v65
    v_exp_f32 v64, v64
    v_mul_f32 v66, s48, v66
    v_exp_f32 v65, v65
    v_mfma_f32_32x32x16_bf16 v[96:111], a[84:87], a[52:55], v[96:111]
    s_waitcnt lgkmcnt(4)
    ds_read_b128 a[76:79], v203
    buffer_load_dwordx4 v2, s[12:15], s38 offen offset:1024 lds
    v_mul_f32 v67, s48, v67
    v_exp_f32 v66, v66
    v_add_f32 v5, v5, v64
    v_mfma_f32_32x32x16_bf16 v[96:111], a[88:91], a[56:59], v[96:111]
    s_waitcnt lgkmcnt(4)
    ds_read_b128 a[80:83], v204
    v_mul_f32 v68, s48, v68
    v_exp_f32 v67, v67
    v_add_f32 v5, v5, v65
    v_mul_f32 v69, s48, v69
    v_exp_f32 v68, v68
    v_mfma_f32_32x32x16_bf16 v[96:111], a[92:95], a[60:63], v[96:111]
    s_waitcnt lgkmcnt(4)
    ds_read_b128 a[84:87], v205
    buffer_load_dwordx4 v3, s[12:15], s38 offen offset:2048 lds
    v_add_f32 v5, v5, v66
    v_cvt_pk_bf16_f32 v40, v64, v65
    v_mul_f32 v70, s48, v70
    v_exp_f32 v69, v69
    v_mfma_f32_32x32x16_bf16 v[112:127], a[64:67], a[0:3], v[112:127]
    s_waitcnt lgkmcnt(4)
    ds_read_b128 a[88:91], v206
    v_add_f32 v5, v5, v67
    v_mul_f32 v71, s48, v71
    v_exp_f32 v70, v70
    v_add_f32 v5, v5, v68
    v_cvt_pk_bf16_f32 v41, v66, v67
    v_mfma_f32_32x32x16_bf16 v[112:127], a[68:71], a[4:7], v[112:127]
    s_waitcnt lgkmcnt(4)
    ds_read_b128 a[92:95], v207
    buffer_load_dwordx4 v4, s[12:15], s38 offen offset:3072 lds
    s_add_u32 s38, s38, 0x80
    v_mul_f32 v72, s48, v72
    v_exp_f32 v71, v71
    v_mfma_f32_32x32x16_bf16 v[112:127], a[72:75], a[8:11], v[112:127]
    s_waitcnt lgkmcnt(4)
    ds_read_b128 a[64:67], v200 offset:8192
    v_add_f32 v5, v5, v69
    v_mul_f32 v73, s48, v73
    v_exp_f32 v72, v72
    v_add_f32 v5, v5, v70
    v_cvt_pk_bf16_f32 v42, v68, v69
    v_mfma_f32_32x32x16_bf16 v[112:127], a[76:79], a[12:15], v[112:127]
    s_waitcnt lgkmcnt(4)
    ds_read_b128 a[68:71], v201 offset:8192
    v_mul_f32 v74, s48, v74
    v_exp_f32 v73, v73
    v_add_f32 v5, v5, v71
    v_mul_f32 v75, s48, v75
    v_exp_f32 v74, v74
    v_mfma_f32_32x32x16_bf16 v[112:127], a[80:83], a[16:19], v[112:127]
    s_waitcnt lgkmcnt(4)
    ds_read_b128 a[72:75], v202 offset:8192
    s_and_b32 s56, s44, 0xffffd000
    s_add_u32 s56, s56, 0xc000
    v_add_u32 v214, s56, v208
    v_add_u32 v215, s56, v209
    v_add_f32 v5, v5, v72
    v_cvt_pk_bf16_f32 v43, v70, v71
    v_mfma_f32_32x32x16_bf16 v[112:127], a[84:87], a[20:23], v[112:127]
    s_waitcnt lgkmcnt(4)
    ds_read_b128 a[76:79], v203 offset:8192
    s_and_b32 s56, s45, 0xffffd000
    s_add_u32 s56, s56, 0xd000
    v_add_u32 v216, s56, v208
    v_add_u32 v217, s56, v209
    v_mul_f32 v76, s48, v76
    v_exp_f32 v75, v75
    v_mfma_f32_32x32x16_bf16 v[112:127], a[88:91], a[24:27], v[112:127]
    s_waitcnt lgkmcnt(4)
    ds_read_b128 a[80:83], v204 offset:8192
    s_and_b32 s56, s46, 0xffffd000
    s_add_u32 s56, s56, 0xe000
    v_add_u32 v218, s56, v208
    v_add_u32 v219, s56, v209
    v_add_f32 v5, v5, v73
    v_mul_f32 v77, s48, v77
    v_mfma_f32_32x32x16_bf16 v[112:127], a[92:95], a[28:31], v[112:127]
    s_waitcnt lgkmcnt(4)
    ds_read_b128 a[84:87], v205 offset:8192
    v_exp_f32 v76, v76
    v_add_f32 v5, v5, v74
    v_cvt_pk_bf16_f32 v44, v72, v73
    v_mul_f32 v78, s48, v78
    v_exp_f32 v77, v77
    v_mfma_f32_32x32x16_bf16 v[112:127], a[64:67], a[32:35], v[112:127]
    s_waitcnt lgkmcnt(4)
    ds_read_b128 a[88:91], v206 offset:8192
    v_add_f32 v5, v5, v75
    v_mul_f32 v79, s48, v79
    v_exp_f32 v78, v78
    v_add_f32 v5, v5, v76
    v_cvt_pk_bf16_f32 v45, v74, v75
    v_exp_f32 v79, v79
    v_add_f32 v5, v5, v77
    v_add_f32 v5, v5, v78
    v_cvt_pk_bf16_f32 v46, v76, v77
    v_add_f32 v5, v5, v79
    v_cvt_pk_bf16_f32 v47, v78, v79
    v_mfma_f32_32x32x16_bf16 v[112:127], a[68:71], a[36:39], v[112:127]
    s_waitcnt lgkmcnt(4)
    s_waitcnt vmcnt(20)
    s_barrier
    s_add_u32 m0, s23, 0
    ds_read_b128 a[92:95], v207 offset:8192
    buffer_load_dwordx4 v1, s[12:15], s36 offen nt lds
    v_mul_f32 v80, s48, v80
    v_mfma_f32_32x32x16_bf16 v[112:127], a[72:75], a[40:43], v[112:127]
    s_waitcnt lgkmcnt(4)
    ds_read_b128 a[64:67], v176
    v_mul_f32 v81, s48, v81
    v_exp_f32 v80, v80
    v_mul_f32 v82, s48, v82
    v_exp_f32 v81, v81
    v_mfma_f32_32x32x16_bf16 v[112:127], a[76:79], a[44:47], v[112:127]
    s_waitcnt lgkmcnt(4)
    ds_read_b128 a[68:71], v177
    buffer_load_dwordx4 v2, s[12:15], s36 offen offset:1024 nt lds
    v_mul_f32 v83, s48, v83
    v_exp_f32 v82, v82
    v_add_f32 v5, v5, v80
    v_mfma_f32_32x32x16_bf16 v[112:127], a[80:83], a[48:51], v[112:127]
    s_waitcnt lgkmcnt(4)
    ds_read_b128 a[72:75], v178
    v_mul_f32 v84, s48, v84
    v_exp_f32 v83, v83
    v_add_f32 v5, v5, v81
    v_mul_f32 v85, s48, v85
    v_exp_f32 v84, v84
    v_mfma_f32_32x32x16_bf16 v[112:127], a[84:87], a[52:55], v[112:127]
    s_waitcnt lgkmcnt(4)
    ds_read_b128 a[76:79], v179
    buffer_load_dwordx4 v3, s[12:15], s36 offen offset:2048 nt lds
    v_add_f32 v5, v5, v82
    v_cvt_pk_bf16_f32 v48, v80, v81
    v_mul_f32 v86, s48, v86
    v_exp_f32 v85, v85
    v_mfma_f32_32x32x16_bf16 v[112:127], a[88:91], a[56:59], v[112:127]
    s_waitcnt lgkmcnt(4)
    ds_read_b128 a[80:83], v180
    v_add_f32 v5, v5, v83
    v_mul_f32 v87, s48, v87
    v_exp_f32 v86, v86
    v_add_f32 v5, v5, v84
    v_cvt_pk_bf16_f32 v49, v82, v83
    v_mfma_f32_32x32x16_bf16 v[112:127], a[92:95], a[60:63], v[112:127]
    s_waitcnt lgkmcnt(4)
    ds_read_b128 a[84:87], v181
    buffer_load_dwordx4 v4, s[12:15], s36 offen offset:3072 nt lds
    s_add_u32 s36, s36, 0x80
    v_mul_f32 v88, s48, v88
    v_exp_f32 v87, v87
    v_mfma_f32_32x32x16_bf16 v[128:143], a[64:67], a[0:3], v[128:143]
    s_waitcnt lgkmcnt(4)
    ds_read_b128 a[88:91], v182
    v_add_f32 v5, v5, v85
    v_mul_f32 v89, s48, v89
    v_exp_f32 v88, v88
    v_add_f32 v5, v5, v86
    v_cvt_pk_bf16_f32 v50, v84, v85
    v_mfma_f32_32x32x16_bf16 v[128:143], a[68:71], a[4:7], v[128:143]
    s_waitcnt lgkmcnt(4)
    ds_read_b128 a[92:95], v183
    v_mul_f32 v90, s48, v90
    v_exp_f32 v89, v89
    v_add_f32 v5, v5, v87
    v_mul_f32 v91, s48, v91
    v_exp_f32 v90, v90
    v_mfma_f32_32x32x16_bf16 v[128:143], a[72:75], a[8:11], v[128:143]
    s_waitcnt lgkmcnt(4)
    ds_read_b128 a[64:67], v176 offset:8192
    v_add_f32 v5, v5, v88
    v_cvt_pk_bf16_f32 v51, v86, v87
    v_mul_f32 v92, s48, v92
    v_exp_f32 v91, v91
    v_add_f32 v5, v5, v89
    v_mfma_f32_32x32x16_bf16 v[128:143], a[76:79], a[12:15], v[128:143]
    s_waitcnt lgkmcnt(4)
    ds_read_b128 a[68:71], v177 offset:8192
    v_mul_f32 v93, s48, v93
    v_exp_f32 v92, v92
    v_add_f32 v5, v5, v90
    v_cvt_pk_bf16_f32 v52, v88, v89
    v_mul_f32 v94, s48, v94
    v_mfma_f32_32x32x16_bf16 v[128:143], a[80:83], a[16:19], v[128:143]
    s_waitcnt lgkmcnt(4)
    ds_read_b128 a[72:75], v178 offset:8192
    v_exp_f32 v93, v93
    v_add_f32 v5, v5, v91
    v_mul_f32 v95, s48, v95
    v_exp_f32 v94, v94
    v_mfma_f32_32x32x16_bf16 v[128:143], a[84:87], a[20:23], v[128:143]
    s_waitcnt lgkmcnt(4)
    ds_read_b128 a[76:79], v179 offset:8192
    v_add_f32 v5, v5, v92
    v_cvt_pk_bf16_f32 v53, v90, v91
    v_exp_f32 v95, v95
    v_add_f32 v5, v5, v93
    v_add_f32 v5, v5, v94
    v_mfma_f32_32x32x16_bf16 v[128:143], a[88:91], a[24:27], v[128:143]
    s_waitcnt lgkmcnt(4)
    ds_read_b128 a[80:83], v180 offset:8192
    v_cvt_pk_bf16_f32 v54, v92, v93
    v_add_f32 v5, v5, v95
    v_cvt_pk_bf16_f32 v55, v94, v95
    v_mul_f32 v96, s48, v96
    v_mul_f32 v97, s48, v97
    v_exp_f32 v96, v96
    v_mfma_f32_32x32x16_bf16 v[128:143], a[92:95], a[28:31], v[128:143]
    s_waitcnt lgkmcnt(4)
    ds_read_b128 a[84:87], v181 offset:8192
    v_mul_f32 v98, s48, v98
    v_exp_f32 v97, v97
    v_mul_f32 v99, s48, v99
    v_exp_f32 v98, v98
    v_mfma_f32_32x32x16_bf16 v[128:143], a[64:67], a[32:35], v[128:143]
    s_waitcnt lgkmcnt(4)
    ds_read_b128 a[88:91], v182 offset:8192
    v_add_f32 v5, v5, v96
    v_mul_f32 v100, s48, v100
    v_exp_f32 v99, v99
    v_add_f32 v5, v5, v97
    v_mul_f32 v101, s48, v101
    v_mfma_f32_32x32x16_bf16 v[128:143], a[68:71], a[36:39], v[128:143]
    s_waitcnt lgkmcnt(4)
    s_waitcnt vmcnt(20)
    s_barrier
    s_add_u32 m0, s23, 0x18000
    ds_read_b128 a[92:95], v183 offset:8192
    buffer_load_dwordx4 v1, s[12:15], s37 offen lds
    v_exp_f32 v100, v100
    v_mfma_f32_32x32x16_bf16 v[128:143], a[72:75], a[40:43], v[128:143]
    s_waitcnt lgkmcnt(4)
    ds_read_b128 a[64:67], v160 offset:16384
    v_add_f32 v5, v5, v98
    v_cvt_pk_bf16_f32 v56, v96, v97
    v_mul_f32 v102, s48, v102
    v_exp_f32 v101, v101
    v_add_f32 v5, v5, v99
    v_mfma_f32_32x32x16_bf16 v[128:143], a[76:79], a[44:47], v[128:143]
    s_waitcnt lgkmcnt(4)
    ds_read_b128 a[68:71], v161 offset:16384
    buffer_load_dwordx4 v2, s[12:15], s37 offen offset:1024 lds
    v_mul_f32 v103, s48, v103
    v_exp_f32 v102, v102
    v_add_f32 v5, v5, v100
    v_mfma_f32_32x32x16_bf16 v[128:143], a[80:83], a[48:51], v[128:143]
    s_waitcnt lgkmcnt(4)
    ds_read_b128 a[72:75], v162 offset:16384
    v_cvt_pk_bf16_f32 v57, v98, v99
    v_mul_f32 v104, s48, v104
    v_exp_f32 v103, v103
    v_add_f32 v5, v5, v101
    v_mul_f32 v105, s48, v105
    v_mfma_f32_32x32x16_bf16 v[128:143], a[84:87], a[52:55], v[128:143]
    s_waitcnt lgkmcnt(4)
    ds_read_b128 a[76:79], v163 offset:16384
    buffer_load_dwordx4 v3, s[12:15], s37 offen offset:2048 lds
    v_exp_f32 v104, v104
    v_add_f32 v5, v5, v102
    v_cvt_pk_bf16_f32 v58, v100, v101
    v_mfma_f32_32x32x16_bf16 v[128:143], a[88:91], a[56:59], v[128:143]
    s_waitcnt lgkmcnt(4)
    ds_read_b128 a[80:83], v164 offset:16384
    v_mul_f32 v106, s48, v106
    v_exp_f32 v105, v105
    v_add_f32 v5, v5, v103
    v_mul_f32 v107, s48, v107
    v_exp_f32 v106, v106
    v_mfma_f32_32x32x16_bf16 v[128:143], a[92:95], a[60:63], v[128:143]
    s_waitcnt lgkmcnt(4)
    ds_read_b128 a[84:87], v165 offset:16384
    buffer_load_dwordx4 v4, s[12:15], s37 offen offset:3072 lds
    s_add_u32 s37, s37, 0x80
    v_add_f32 v5, v5, v104
    v_cvt_pk_bf16_f32 v59, v102, v103
    v_mul_f32 v108, s48, v108
    v_mfma_f32_32x32x16_bf16 v[144:159], a[64:67], a[0:3], v[144:159]
    s_waitcnt lgkmcnt(4)
    ds_read_b128 a[88:91], v166 offset:16384
    v_exp_f32 v107, v107
    v_add_f32 v5, v5, v105
    v_mul_f32 v109, s48, v109
    v_exp_f32 v108, v108
    v_mfma_f32_32x32x16_bf16 v[144:159], a[68:71], a[4:7], v[144:159]
    s_waitcnt lgkmcnt(4)
    s_add_u32 m0, s23, 0x1c000
    ds_read_b128 a[92:95], v167 offset:16384
    buffer_load_dwordx4 v1, s[12:15], s38 offen lds
    v_add_f32 v5, v5, v106
    v_cvt_pk_bf16_f32 v60, v104, v105
    v_mul_f32 v110, s48, v110
    v_mfma_f32_32x32x16_bf16 v[144:159], a[72:75], a[8:11], v[144:159]
    s_waitcnt lgkmcnt(4)
    ds_read_b128 a[64:67], v160 offset:24576
    v_exp_f32 v109, v109
    v_add_f32 v5, v5, v107
    v_mul_f32 v111, s48, v111
    v_exp_f32 v110, v110
    v_mfma_f32_32x32x16_bf16 v[144:159], a[76:79], a[12:15], v[144:159]
    s_waitcnt lgkmcnt(4)
    ds_read_b128 a[68:71], v161 offset:24576
    buffer_load_dwordx4 v2, s[12:15], s38 offen offset:1024 lds
    v_add_f32 v5, v5, v108
    v_cvt_pk_bf16_f32 v61, v106, v107
    v_exp_f32 v111, v111
    v_mfma_f32_32x32x16_bf16 v[144:159], a[80:83], a[16:19], v[144:159]
    s_waitcnt lgkmcnt(4)
    ds_read_b128 a[72:75], v162 offset:24576
    v_add_f32 v5, v5, v109
    v_add_f32 v5, v5, v110
    v_cvt_pk_bf16_f32 v62, v108, v109
    v_add_f32 v5, v5, v111
    v_cvt_pk_bf16_f32 v63, v110, v111
    v_mul_f32 v112, s48, v112
    v_mfma_f32_32x32x16_bf16 v[144:159], a[84:87], a[20:23], v[144:159]
    s_waitcnt lgkmcnt(4)
    ds_read_b128 a[76:79], v163 offset:24576
    buffer_load_dwordx4 v3, s[12:15], s38 offen offset:2048 lds
    v_mul_f32 v113, s48, v113
    v_exp_f32 v112, v112
    v_mul_f32 v114, s48, v114
    v_mfma_f32_32x32x16_bf16 v[144:159], a[88:91], a[24:27], v[144:159]
    s_waitcnt lgkmcnt(4)
    ds_read_b128 a[80:83], v164 offset:24576
    v_exp_f32 v113, v113
    v_mul_f32 v115, s48, v115
    v_exp_f32 v114, v114
    v_add_f32 v5, v5, v112
    v_mfma_f32_32x32x16_bf16 v[144:159], a[92:95], a[28:31], v[144:159]
    s_waitcnt lgkmcnt(4)
    ds_read_b128 a[84:87], v165 offset:24576
    buffer_load_dwordx4 v4, s[12:15], s38 offen offset:3072 lds
    s_add_u32 s38, s38, 0x80
    v_mul_f32 v116, s48, v116
    v_exp_f32 v115, v115
    v_mfma_f32_32x32x16_bf16 v[144:159], a[64:67], a[32:35], v[144:159]
    s_waitcnt lgkmcnt(4)
    ds_read_b128 a[88:91], v166 offset:24576
    v_add_f32 v5, v5, v113
    v_mul_f32 v117, s48, v117
    v_exp_f32 v116, v116
    v_add_f32 v5, v5, v114
    v_cvt_pk_bf16_f32 v64, v112, v113
    v_mfma_f32_32x32x16_bf16 v[144:159], a[68:71], a[36:39], v[144:159]
    s_waitcnt lgkmcnt(4)
    s_waitcnt vmcnt(16)
    s_barrier
    s_add_u32 m0, s23, 0x20000
    ds_read_b128 a[92:95], v167 offset:24576
    buffer_load_dwordx4 v1, s[12:15], s38 offen lds
    v_mul_f32 v118, s48, v118
    v_mfma_f32_32x32x16_bf16 v[144:159], a[72:75], a[40:43], v[144:159]
    s_waitcnt lgkmcnt(4)
    ds_read_b64_tr_b16 a[64:65], v210
    ds_read_b64_tr_b16 a[66:67], v210 offset:1024
    v_exp_f32 v117, v117
    v_add_f32 v5, v5, v115
    v_mul_f32 v119, s48, v119
    v_exp_f32 v118, v118
    v_mfma_f32_32x32x16_bf16 v[144:159], a[76:79], a[44:47], v[144:159]
    s_waitcnt lgkmcnt(5)
    ds_read_b64_tr_b16 a[68:69], v211
    ds_read_b64_tr_b16 a[70:71], v211 offset:1024
    buffer_load_dwordx4 v2, s[12:15], s38 offen offset:1024 lds
    v_add_f32 v5, v5, v116
    v_cvt_pk_bf16_f32 v65, v114, v115
    v_mul_f32 v120, s48, v120
    v_mfma_f32_32x32x16_bf16 v[144:159], a[80:83], a[48:51], v[144:159]
    s_waitcnt lgkmcnt(6)
    ds_read_b64_tr_b16 a[72:73], v210 offset:2048
    ds_read_b64_tr_b16 a[74:75], v210 offset:3072
    v_exp_f32 v119, v119
    v_add_f32 v5, v5, v117
    v_mul_f32 v121, s48, v121
    v_exp_f32 v120, v120
    v_mfma_f32_32x32x16_bf16 v[144:159], a[84:87], a[52:55], v[144:159]
    s_waitcnt lgkmcnt(7)
    ds_read_b64_tr_b16 a[76:77], v211 offset:2048
    ds_read_b64_tr_b16 a[78:79], v211 offset:3072
    buffer_load_dwordx4 v3, s[12:15], s38 offen offset:2048 lds
    v_add_f32 v5, v5, v118
    v_cvt_pk_bf16_f32 v66, v116, v117
    v_mul_f32 v122, s48, v122
    v_mfma_f32_32x32x16_bf16 v[144:159], a[88:91], a[56:59], v[144:159]
    s_waitcnt lgkmcnt(8)
    ds_read_b64_tr_b16 a[80:81], v210 offset:4096
    ds_read_b64_tr_b16 a[82:83], v210 offset:5120
    v_exp_f32 v121, v121
    v_add_f32 v5, v5, v119
    v_mul_f32 v123, s48, v123
    v_exp_f32 v122, v122
    v_mfma_f32_32x32x16_bf16 v[144:159], a[92:95], a[60:63], v[144:159]
    s_waitcnt lgkmcnt(8)
    ds_read_b64_tr_b16 a[84:85], v211 offset:4096
    ds_read_b64_tr_b16 a[86:87], v211 offset:5120
    buffer_load_dwordx4 v4, s[12:15], s38 offen offset:3072 lds
    v_add_f32 v5, v5, v120
    v_cvt_pk_bf16_f32 v67, v118, v119
    v_mul_f32 v124, s48, v124
    v_exp_f32 v123, v123
    v_add_f32 v5, v5, v121
    v_mul_f32 v125, s48, v125
    v_exp_f32 v124, v124
    v_add_f32 v5, v5, v122
    v_cvt_pk_bf16_f32 v68, v120, v121
    v_mul_f32 v126, s48, v126
    v_exp_f32 v125, v125
    v_add_f32 v5, v5, v123
    v_mul_f32 v127, s48, v127
    v_exp_f32 v126, v126
    v_add_f32 v5, v5, v124
    v_cvt_pk_bf16_f32 v69, v122, v123
    v_exp_f32 v127, v127
    v_add_f32 v5, v5, v125
    v_add_f32 v5, v5, v126
    v_cvt_pk_bf16_f32 v70, v124, v125
    v_add_f32 v5, v5, v127
    v_cvt_pk_bf16_f32 v71, v126, v127
    v_mfma_f32_32x32x16_bf16 v[96:111], a[64:67], v[24:27], 0
    s_waitcnt lgkmcnt(8)
    ds_read_b64_tr_b16 a[88:89], v210 offset:6144
    ds_read_b64_tr_b16 a[90:91], v210 offset:7168
    v_mul_f32 v128, s48, v128
    v_mul_f32 v129, s48, v129
    v_exp_f32 v128, v128
    v_mul_f32 v130, s48, v130
    v_mfma_f32_32x32x16_bf16 v[112:127], a[68:71], v[24:27], 0
    s_waitcnt lgkmcnt(8)
    ds_read_b64_tr_b16 a[92:93], v211 offset:6144
    ds_read_b64_tr_b16 a[94:95], v211 offset:7168
    v_exp_f32 v129, v129
    v_mul_f32 v131, s48, v131
    v_exp_f32 v130, v130
    v_mfma_f32_32x32x16_bf16 v[96:111], a[72:75], v[28:31], v[96:111]
    s_waitcnt lgkmcnt(8)
    ds_read_b64_tr_b16 a[64:65], v210 offset:8192
    ds_read_b64_tr_b16 a[66:67], v210 offset:9216
    v_add_f32 v5, v5, v128
    v_mul_f32 v132, s48, v132
    v_exp_f32 v131, v131
    v_add_f32 v5, v5, v129
    v_mfma_f32_32x32x16_bf16 v[112:127], a[76:79], v[28:31], v[112:127]
    s_waitcnt lgkmcnt(8)
    ds_read_b64_tr_b16 a[68:69], v211 offset:8192
    ds_read_b64_tr_b16 a[70:71], v211 offset:9216
    v_mul_f32 v133, s48, v133
    v_exp_f32 v132, v132
    v_add_f32 v5, v5, v130
    v_cvt_pk_bf16_f32 v72, v128, v129
    v_mfma_f32_32x32x16_bf16 v[96:111], a[80:83], v[40:43], v[96:111]
    s_waitcnt lgkmcnt(8)
    ds_read_b64_tr_b16 a[72:73], v210 offset:10240
    ds_read_b64_tr_b16 a[74:75], v210 offset:11264
    v_mul_f32 v134, s48, v134
    v_exp_f32 v133, v133
    v_add_f32 v5, v5, v131
    v_mul_f32 v135, s48, v135
    v_mfma_f32_32x32x16_bf16 v[112:127], a[84:87], v[40:43], v[112:127]
    s_waitcnt lgkmcnt(8)
    ds_read_b64_tr_b16 a[76:77], v211 offset:10240
    ds_read_b64_tr_b16 a[78:79], v211 offset:11264
    v_exp_f32 v134, v134
    v_add_f32 v5, v5, v132
    v_cvt_pk_bf16_f32 v73, v130, v131
    v_mul_f32 v136, s48, v136
    v_mfma_f32_32x32x16_bf16 v[96:111], a[88:91], v[44:47], v[96:111]
    s_waitcnt lgkmcnt(8)
    ds_read_b64_tr_b16 a[80:81], v210 offset:12288
    ds_read_b64_tr_b16 a[82:83], v210 offset:13312
    v_exp_f32 v135, v135
    v_add_f32 v5, v5, v133
    v_mul_f32 v137, s48, v137
    v_exp_f32 v136, v136
    v_mfma_f32_32x32x16_bf16 v[112:127], a[92:95], v[44:47], v[112:127]
    s_waitcnt lgkmcnt(8)
    ds_read_b64_tr_b16 a[84:85], v211 offset:12288
    ds_read_b64_tr_b16 a[86:87], v211 offset:13312
    v_add_f32 v5, v5, v134
    v_cvt_pk_bf16_f32 v74, v132, v133
    v_mul_f32 v138, s48, v138
    v_exp_f32 v137, v137
    v_mfma_f32_32x32x16_bf16 v[96:111], a[64:67], v[56:59], v[96:111]
    s_waitcnt lgkmcnt(8)
    ds_read_b64_tr_b16 a[88:89], v210 offset:14336
    ds_read_b64_tr_b16 a[90:91], v210 offset:15360
    v_add_f32 v5, v5, v135
    v_mul_f32 v139, s48, v139
    v_exp_f32 v138, v138
    v_add_f32 v5, v5, v136
    v_mfma_f32_32x32x16_bf16 v[112:127], a[68:71], v[56:59], v[112:127]
    s_waitcnt lgkmcnt(8)
    s_barrier
    s_add_u32 m0, s23, 0x4000
    ds_read_b64_tr_b16 a[92:93], v211 offset:14336
    ds_read_b64_tr_b16 a[94:95], v211 offset:15360
    buffer_load_dwordx4 v1, s[12:15], s37 offen lds
    v_mfma_f32_32x32x16_bf16 v[96:111], a[72:75], v[60:63], v[96:111]
    s_waitcnt lgkmcnt(8)
    ds_read_b64_tr_b16 a[64:65], v208 offset:32768
    ds_read_b64_tr_b16 a[66:67], v208 offset:33792
    v_cvt_pk_bf16_f32 v75, v134, v135
    v_mul_f32 v140, s48, v140
    v_exp_f32 v139, v139
    v_add_f32 v5, v5, v137
    v_mfma_f32_32x32x16_bf16 v[112:127], a[76:79], v[60:63], v[112:127]
    s_waitcnt lgkmcnt(8)
    ds_read_b64_tr_b16 a[68:69], v209 offset:32768
    ds_read_b64_tr_b16 a[70:71], v209 offset:33792
    buffer_load_dwordx4 v2, s[12:15], s37 offen offset:1024 lds
    v_mul_f32 v141, s48, v141
    v_exp_f32 v140, v140
    v_add_f32 v5, v5, v138
    v_cvt_pk_bf16_f32 v76, v136, v137
    v_mul_f32 v142, s48, v142
    v_exp_f32 v141, v141
    v_add_f32 v5, v5, v139
    v_mul_f32 v143, s48, v143
    v_exp_f32 v142, v142
    v_add_f32 v5, v5, v140
    v_cvt_pk_bf16_f32 v77, v138, v139
    v_exp_f32 v143, v143
    v_add_f32 v5, v5, v141
    v_add_f32 v5, v5, v142
    v_cvt_pk_bf16_f32 v78, v140, v141
    v_add_f32 v5, v5, v143
    v_cvt_pk_bf16_f32 v79, v142, v143
    v_mfma_f32_32x32x16_bf16 v[96:111], a[80:83], v[72:75], v[96:111]
    s_waitcnt lgkmcnt(8)
    ds_read_b64_tr_b16 a[72:73], v208 offset:34816
    ds_read_b64_tr_b16 a[74:75], v208 offset:35840
    v_mul_f32 v144, s48, v144
    v_mul_f32 v145, s48, v145
    v_exp_f32 v144, v144
    v_mul_f32 v146, s48, v146
    v_mfma_f32_32x32x16_bf16 v[112:127], a[84:87], v[72:75], v[112:127]
    s_waitcnt lgkmcnt(8)
    ds_read_b64_tr_b16 a[76:77], v209 offset:34816
    ds_read_b64_tr_b16 a[78:79], v209 offset:35840
    buffer_load_dwordx4 v3, s[12:15], s37 offen offset:2048 lds
    v_exp_f32 v145, v145
    v_mul_f32 v147, s48, v147
    v_mfma_f32_32x32x16_bf16 v[96:111], a[88:91], v[76:79], v[96:111]
    s_waitcnt lgkmcnt(8)
    ds_read_b64_tr_b16 a[80:81], v214
    ds_read_b64_tr_b16 a[82:83], v214 offset:1024
    v_exp_f32 v146, v146
    v_add_f32 v5, v5, v144
    v_mul_f32 v148, s48, v148
    v_exp_f32 v147, v147
    v_mfma_f32_32x32x16_bf16 v[112:127], a[92:95], v[76:79], v[112:127]
    s_waitcnt lgkmcnt(8)
    ds_read_b64_tr_b16 a[84:85], v215
    ds_read_b64_tr_b16 a[86:87], v215 offset:1024
    buffer_load_dwordx4 v4, s[12:15], s37 offen offset:3072 lds
    s_add_u32 s37, s37, 0x80
    v_add_f32 v5, v5, v145
    v_mul_f32 v149, s48, v149
    v_mfma_f32_32x32x16_bf16 v[96:111], a[64:67], v[16:19], v[96:111]
    s_waitcnt lgkmcnt(8)
    ds_read_b64_tr_b16 a[88:89], v214 offset:2048
    ds_read_b64_tr_b16 a[90:91], v214 offset:3072
    v_exp_f32 v148, v148
    v_add_f32 v5, v5, v146
    v_cvt_pk_bf16_f32 v80, v144, v145
    v_mul_f32 v150, s48, v150
    v_mfma_f32_32x32x16_bf16 v[112:127], a[68:71], v[16:19], v[112:127]
    s_waitcnt lgkmcnt(8)
    ds_read_b64_tr_b16 a[92:93], v215 offset:2048
    ds_read_b64_tr_b16 a[94:95], v215 offset:3072
    v_exp_f32 v149, v149
    v_add_f32 v5, v5, v147
    v_mul_f32 v151, s48, v151
    v_exp_f32 v150, v150
    v_mfma_f32_32x32x16_bf16 v[96:111], a[72:75], v[20:23], v[96:111]
    s_waitcnt lgkmcnt(8)
    ds_read_b64_tr_b16 a[64:65], v216
    ds_read_b64_tr_b16 a[66:67], v216 offset:1024
    s_and_b32 s56, s44, 0x15000
    s_add_u32 s56, s56, 0
    v_add_u32 v214, s56, v208
    v_add_u32 v215, s56, v209
    v_add_f32 v5, v5, v148
    v_mfma_f32_32x32x16_bf16 v[112:127], a[76:79], v[20:23], v[112:127]
    s_waitcnt lgkmcnt(8)
    ds_read_b64_tr_b16 a[68:69], v217
    ds_read_b64_tr_b16 a[70:71], v217 offset:1024
    v_cvt_pk_bf16_f32 v81, v146, v147
    v_mul_f32 v152, s48, v152
    v_exp_f32 v151, v151
    v_add_f32 v5, v5, v149
    v_mfma_f32_32x32x16_bf16 v[96:111], a[80:83], v[32:35], v[96:111]
    s_waitcnt lgkmcnt(8)
    ds_read_b64_tr_b16 a[72:73], v216 offset:2048
    ds_read_b64_tr_b16 a[74:75], v216 offset:3072
    v_mul_f32 v153, s48, v153
    v_exp_f32 v152, v152
    v_add_f32 v5, v5, v150
    v_cvt_pk_bf16_f32 v82, v148, v149
    v_mfma_f32_32x32x16_bf16 v[112:127], a[84:87], v[32:35], v[112:127]
    s_waitcnt lgkmcnt(8)
    ds_read_b64_tr_b16 a[76:77], v217 offset:2048
    ds_read_b64_tr_b16 a[78:79], v217 offset:3072
    v_mul_f32 v154, s48, v154
    v_exp_f32 v153, v153
    v_add_f32 v5, v5, v151
    v_mul_f32 v155, s48, v155
    v_mfma_f32_32x32x16_bf16 v[96:111], a[88:91], v[36:39], v[96:111]
    s_waitcnt lgkmcnt(8)
    ds_read_b64_tr_b16 a[80:81], v218
    ds_read_b64_tr_b16 a[82:83], v218 offset:1024
    s_and_b32 s56, s45, 0x15000
    s_add_u32 s56, s56, 0x1000
    v_add_u32 v216, s56, v208
    v_add_u32 v217, s56, v209
    v_exp_f32 v154, v154
    v_mfma_f32_32x32x16_bf16 v[112:127], a[92:95], v[36:39], v[112:127]
    s_waitcnt lgkmcnt(8)
    ds_read_b64_tr_b16 a[84:85], v219
    ds_read_b64_tr_b16 a[86:87], v219 offset:1024
    v_add_f32 v5, v5, v152
    v_cvt_pk_bf16_f32 v83, v150, v151
    v_mul_f32 v156, s48, v156
    v_exp_f32 v155, v155
    v_mfma_f32_32x32x16_bf16 v[96:111], a[64:67], v[48:51], v[96:111]
    s_waitcnt lgkmcnt(8)
    ds_read_b64_tr_b16 a[88:89], v218 offset:2048
    ds_read_b64_tr_b16 a[90:91], v218 offset:3072
    v_add_f32 v5, v5, v153
    v_mul_f32 v157, s48, v157
    v_exp_f32 v156, v156
    v_add_f32 v5, v5, v154
    v_mfma_f32_32x32x16_bf16 v[112:127], a[68:71], v[48:51], v[112:127]
    s_waitcnt lgkmcnt(8)
    ds_read_b64_tr_b16 a[92:93], v219 offset:2048
    ds_read_b64_tr_b16 a[94:95], v219 offset:3072
    v_cvt_pk_bf16_f32 v84, v152, v153
    v_mul_f32 v158, s48, v158
    v_exp_f32 v157, v157
    v_add_f32 v5, v5, v155
    v_mfma_f32_32x32x16_bf16 v[96:111], a[72:75], v[52:55], v[96:111]
    s_waitcnt lgkmcnt(8)
    ds_read_b64_tr_b16 a[64:65], v208 offset:61440
    ds_read_b64_tr_b16 a[66:67], v208 offset:62464
    s_and_b32 s56, s46, 0x15000
    s_add_u32 s56, s56, 0x2000
    v_add_u32 v218, s56, v208
    v_add_u32 v219, s56, v209
    v_mul_f32 v159, s48, v159
    v_mfma_f32_32x32x16_bf16 v[112:127], a[76:79], v[52:55], v[112:127]
    s_waitcnt lgkmcnt(8)
    ds_read_b64_tr_b16 a[68:69], v208 offset:63488
    ds_read_b64_tr_b16 a[70:71], v208 offset:64512
    v_exp_f32 v158, v158
    v_add_f32 v5, v5, v156
    v_cvt_pk_bf16_f32 v85, v154, v155
    v_exp_f32 v159, v159
    v_mfma_f32_32x32x16_bf16 v[96:111], a[80:83], v[64:67], v[96:111]
    s_waitcnt lgkmcnt(8)
    ds_read_b64_tr_b16 a[72:73], v209 offset:61440
    ds_read_b64_tr_b16 a[74:75], v209 offset:62464
    v_add_f32 v5, v5, v157
    v_add_f32 v5, v5, v158
    v_cvt_pk_bf16_f32 v86, v156, v157
    v_add_f32 v5, v5, v159
    v_cvt_pk_bf16_f32 v87, v158, v159
    v_mfma_f32_32x32x16_bf16 v[112:127], a[84:87], v[64:67], v[112:127]
    s_waitcnt lgkmcnt(8)
    s_waitcnt vmcnt(12)
    s_barrier
    s_add_u32 m0, s23, 0x10000
    ds_read_b64_tr_b16 a[76:77], v209 offset:63488
    ds_read_b64_tr_b16 a[78:79], v209 offset:64512
    buffer_load_dwordx4 v1, s[12:15], s36 offen nt lds
    v_mfma_f32_32x32x16_bf16 v[96:111], a[88:91], v[68:71], v[96:111]
    s_waitcnt lgkmcnt(8)
    ds_read_b64_tr_b16 a[80:81], v210 offset:32768
    ds_read_b64_tr_b16 a[82:83], v210 offset:33792
    v_mov_b32 v244, v5
    s_lshl_b32 s55, s20, 2
    s_add_u32 s55, s55, 0x18000
    v_permlane32_swap_b32 v5, v244
    v_mov_b32 v245, s55
    v_mfma_f32_32x32x16_bf16 v[112:127], a[92:95], v[68:71], v[112:127]
    s_waitcnt lgkmcnt(8)
    ds_read_b64_tr_b16 a[84:85], v211 offset:32768
    ds_read_b64_tr_b16 a[86:87], v211 offset:33792
    buffer_load_dwordx4 v2, s[12:15], s36 offen offset:1024 nt lds
    v_add_f32 v5, v5, v244
    v_mov_b32 v247, 0x18000
    v_rcp_f32 v15, v5
    v_mfma_f32_32x32x16_bf16 v[96:111], a[64:67], v[80:83], v[96:111]
    s_waitcnt lgkmcnt(8)
    ds_read_b64_tr_b16 a[88:89], v210 offset:34816
    ds_read_b64_tr_b16 a[90:91], v210 offset:35840
    v_cmp_nle_f32 vcc, s51, v5
    v_cmp_nge_f32 s[62:63], s49, v5
    s_nop 3
    s_or_b64 vcc, vcc, s[62:63]
    s_cselect_b32 s55, 1, 0
    v_mfma_f32_32x32x16_bf16 v[96:111], a[68:71], v[84:87], v[96:111]
    s_waitcnt lgkmcnt(8)
    ds_read_b64_tr_b16 a[92:93], v211 offset:34816
    ds_read_b64_tr_b16 a[94:95], v211 offset:35840
    buffer_load_dwordx4 v3, s[12:15], s36 offen offset:2048 nt lds
    v_mov_b32 v246, s55
    v_mfma_f32_32x32x16_bf16 v[112:127], a[72:75], v[80:83], v[112:127]
    s_waitcnt lgkmcnt(8)
    ds_read_b64_tr_b16 a[64:65], v210 offset:36864
    ds_read_b64_tr_b16 a[66:67], v210 offset:37888
    v_mfma_f32_32x32x16_bf16 v[112:127], a[76:79], v[84:87], v[112:127]
    s_waitcnt lgkmcnt(8)
    ds_read_b64_tr_b16 a[68:69], v211 offset:36864
    ds_read_b64_tr_b16 a[70:71], v211 offset:37888
    buffer_load_dwordx4 v4, s[12:15], s36 offen offset:3072 nt lds
    s_add_u32 s36, s36, 0x80
    v_mfma_f32_32x32x16_bf16 v[128:143], a[80:83], v[24:27], 0
    s_waitcnt lgkmcnt(8)
    ds_read_b64_tr_b16 a[72:73], v210 offset:38912
    ds_read_b64_tr_b16 a[74:75], v210 offset:39936
    v_mfma_f32_32x32x16_bf16 v[144:159], a[84:87], v[24:27], 0
    s_waitcnt lgkmcnt(8)
    ds_read_b64_tr_b16 a[76:77], v211 offset:38912
    ds_read_b64_tr_b16 a[78:79], v211 offset:39936
    v_mul_f32 v96, v96, v15
    v_mul_f32 v97, v97, v15
    v_mul_f32 v98, v98, v15
    v_mul_f32 v99, v99, v15
    v_mul_f32 v100, v100, v15
    v_mfma_f32_32x32x16_bf16 v[128:143], a[88:91], v[28:31], v[128:143]
    s_waitcnt lgkmcnt(8)
    ds_read_b64_tr_b16 a[80:81], v210 offset:40960
    ds_read_b64_tr_b16 a[82:83], v210 offset:41984
    v_mul_f32 v101, v101, v15
    v_mul_f32 v102, v102, v15
    v_mul_f32 v103, v103, v15
    v_cvt_pk_bf16_f32 v96, v96, v97
    v_cvt_pk_bf16_f32 v97, v98, v99
    v_mfma_f32_32x32x16_bf16 v[144:159], a[92:95], v[28:31], v[144:159]
    s_waitcnt lgkmcnt(8)
    ds_read_b64_tr_b16 a[84:85], v211 offset:40960
    ds_read_b64_tr_b16 a[86:87], v211 offset:41984
    v_cvt_pk_bf16_f32 v98, v100, v101
    v_cvt_pk_bf16_f32 v99, v102, v103
    v_mul_f32 v104, v104, v15
    v_mul_f32 v105, v105, v15
    v_mul_f32 v106, v106, v15
    v_mfma_f32_32x32x16_bf16 v[128:143], a[64:67], v[40:43], v[128:143]
    s_waitcnt lgkmcnt(8)
    ds_read_b64_tr_b16 a[88:89], v210 offset:43008
    ds_read_b64_tr_b16 a[90:91], v210 offset:44032
    ds_write_b64 v6, v[96:97]
    v_mul_f32 v107, v107, v15
    v_mul_f32 v108, v108, v15
    v_mfma_f32_32x32x16_bf16 v[144:159], a[68:71], v[40:43], v[144:159]
    s_waitcnt lgkmcnt(9)
    ds_read_b64_tr_b16 a[92:93], v211 offset:43008
    ds_read_b64_tr_b16 a[94:95], v211 offset:44032
    ds_write_b64 v6, v[98:99] offset:8
    v_mul_f32 v109, v109, v15
    v_mul_f32 v110, v110, v15
    v_mfma_f32_32x32x16_bf16 v[128:143], a[72:75], v[44:47], v[128:143]
    s_waitcnt lgkmcnt(10)
    ds_read_b64_tr_b16 a[64:65], v210 offset:45056
    ds_read_b64_tr_b16 a[66:67], v210 offset:46080
    v_mul_f32 v111, v111, v15
    v_cvt_pk_bf16_f32 v100, v104, v105
    v_cvt_pk_bf16_f32 v101, v106, v107
    v_cvt_pk_bf16_f32 v102, v108, v109
    v_cvt_pk_bf16_f32 v103, v110, v111
    v_mfma_f32_32x32x16_bf16 v[144:159], a[76:79], v[44:47], v[144:159]
    s_waitcnt lgkmcnt(10)
    ds_read_b64_tr_b16 a[68:69], v211 offset:45056
    ds_read_b64_tr_b16 a[70:71], v211 offset:46080
    ds_write_b64 v7, v[100:101]
    v_mul_f32 v112, v112, v15
    v_mul_f32 v113, v113, v15
    v_mfma_f32_32x32x16_bf16 v[128:143], a[80:83], v[56:59], v[128:143]
    s_waitcnt lgkmcnt(11)
    ds_read_b64_tr_b16 a[72:73], v210 offset:47104
    ds_read_b64_tr_b16 a[74:75], v210 offset:48128
    ds_write_b64 v7, v[102:103] offset:8
    v_mul_f32 v114, v114, v15
    v_mul_f32 v115, v115, v15
    v_mfma_f32_32x32x16_bf16 v[144:159], a[84:87], v[56:59], v[144:159]
    s_waitcnt lgkmcnt(12)
    s_barrier
    s_add_u32 m0, s23, 0x8000
    ds_read_b64_tr_b16 a[76:77], v211 offset:47104
    ds_read_b64_tr_b16 a[78:79], v211 offset:48128
    buffer_load_dwordx4 v1, s[12:15], s37 offen lds
    v_mfma_f32_32x32x16_bf16 v[128:143], a[88:91], v[60:63], v[128:143]
    s_waitcnt lgkmcnt(11)
    ds_read_b64_tr_b16 a[80:81], v210 offset:16384
    ds_read_b64_tr_b16 a[82:83], v210 offset:17408
    v_mul_f32 v116, v116, v15
    v_mul_f32 v117, v117, v15
    v_mul_f32 v118, v118, v15
    v_mul_f32 v119, v119, v15
    v_cvt_pk_bf16_f32 v112, v112, v113
    v_mfma_f32_32x32x16_bf16 v[144:159], a[92:95], v[60:63], v[144:159]
    s_waitcnt lgkmcnt(10)
    ds_read_b64_tr_b16 a[84:85], v211 offset:16384
    ds_read_b64_tr_b16 a[86:87], v211 offset:17408
    buffer_load_dwordx4 v2, s[12:15], s37 offen offset:1024 lds
    v_cvt_pk_bf16_f32 v113, v114, v115
    v_cvt_pk_bf16_f32 v114, v116, v117
    v_cvt_pk_bf16_f32 v115, v118, v119
    v_mfma_f32_32x32x16_bf16 v[128:143], a[64:67], v[72:75], v[128:143]
    s_waitcnt lgkmcnt(10)
    ds_read_b64_tr_b16 a[88:89], v210 offset:18432
    ds_read_b64_tr_b16 a[90:91], v210 offset:19456
    ds_write_b64 v8, v[112:113]
    v_mul_f32 v120, v120, v15
    v_mul_f32 v121, v121, v15
    v_mfma_f32_32x32x16_bf16 v[144:159], a[68:71], v[72:75], v[144:159]
    s_waitcnt lgkmcnt(10)
    ds_read_b64_tr_b16 a[92:93], v211 offset:18432
    ds_read_b64_tr_b16 a[94:95], v211 offset:19456
    ds_write_b64 v8, v[114:115] offset:8
    buffer_load_dwordx4 v3, s[12:15], s37 offen offset:2048 lds
    v_mfma_f32_32x32x16_bf16 v[128:143], a[72:75], v[76:79], v[128:143]
    s_waitcnt lgkmcnt(10)
    ds_read_b64_tr_b16 a[64:65], v214
    ds_read_b64_tr_b16 a[66:67], v214 offset:1024
    v_mul_f32 v122, v122, v15
    v_mul_f32 v123, v123, v15
    v_mul_f32 v124, v124, v15
    v_mul_f32 v125, v125, v15
    v_mul_f32 v126, v126, v15
    v_mfma_f32_32x32x16_bf16 v[144:159], a[76:79], v[76:79], v[144:159]
    s_waitcnt lgkmcnt(10)
    ds_read_b64_tr_b16 a[68:69], v215
    ds_read_b64_tr_b16 a[70:71], v215 offset:1024
    buffer_load_dwordx4 v4, s[12:15], s37 offen offset:3072 lds
    v_mul_f32 v127, v127, v15
    v_cvt_pk_bf16_f32 v116, v120, v121
    v_cvt_pk_bf16_f32 v117, v122, v123
    v_mfma_f32_32x32x16_bf16 v[128:143], a[80:83], v[16:19], v[128:143]
    s_waitcnt lgkmcnt(10)
    ds_read_b64_tr_b16 a[72:73], v214 offset:2048
    ds_read_b64_tr_b16 a[74:75], v214 offset:3072
    v_cvt_pk_bf16_f32 v118, v124, v125
    v_cvt_pk_bf16_f32 v119, v126, v127
    v_mfma_f32_32x32x16_bf16 v[144:159], a[84:87], v[16:19], v[144:159]
    s_waitcnt lgkmcnt(10)
    s_add_u32 m0, s23, 0xc000
    ds_read_b64_tr_b16 a[76:77], v215 offset:2048
    ds_read_b64_tr_b16 a[78:79], v215 offset:3072
    ds_write_b64 v9, v[116:117]
    buffer_load_dwordx4 v1, s[12:15], s36 offen nt lds
    v_mfma_f32_32x32x16_bf16 v[128:143], a[88:91], v[20:23], v[128:143]
    s_waitcnt lgkmcnt(10)
    ds_read_b64_tr_b16 a[80:81], v216
    ds_read_b64_tr_b16 a[82:83], v216 offset:1024
    ds_write_b64 v9, v[118:119] offset:8
    v_mfma_f32_32x32x16_bf16 v[144:159], a[92:95], v[20:23], v[144:159]
    s_waitcnt lgkmcnt(10)
    ds_read_b64_tr_b16 a[84:85], v217
    ds_read_b64_tr_b16 a[86:87], v217 offset:1024
    ds_read_b128 v[104:107], v10
    buffer_load_dwordx4 v2, s[12:15], s36 offen offset:1024 nt lds
    v_mfma_f32_32x32x16_bf16 v[128:143], a[64:67], v[32:35], v[128:143]
    s_waitcnt lgkmcnt(11)
    ds_read_b64_tr_b16 a[88:89], v216 offset:2048
    ds_read_b64_tr_b16 a[90:91], v216 offset:3072
    ds_read_b128 v[108:111], v10 offset:1024
    s_and_b32 s56, s44, 0xd000
    s_add_u32 s56, s56, 0x10000
    v_add_u32 v214, s56, v208
    v_add_u32 v215, s56, v209
    v_mfma_f32_32x32x16_bf16 v[144:159], a[68:71], v[32:35], v[144:159]
    s_waitcnt lgkmcnt(12)
    ds_read_b64_tr_b16 a[92:93], v217 offset:2048
    ds_read_b64_tr_b16 a[94:95], v217 offset:3072
    ds_read_b128 v[120:123], v10 offset:2048
    buffer_load_dwordx4 v3, s[12:15], s36 offen offset:2048 nt lds
    v_mfma_f32_32x32x16_bf16 v[128:143], a[72:75], v[36:39], v[128:143]
    s_waitcnt lgkmcnt(13)
    ds_read_b64_tr_b16 a[64:65], v218
    ds_read_b64_tr_b16 a[66:67], v218 offset:1024
    s_waitcnt lgkmcnt(14)
    ds_read_b128 v[124:127], v10 offset:3072
    s_and_b32 s56, s45, 0xd000
    s_add_u32 s56, s56, 0x11000
    v_add_u32 v216, s56, v208
    v_add_u32 v217, s56, v209
    v_mfma_f32_32x32x16_bf16 v[144:159], a[76:79], v[36:39], v[144:159]
    s_waitcnt lgkmcnt(13)
    ds_read_b64_tr_b16 a[68:69], v219
    ds_read_b64_tr_b16 a[70:71], v219 offset:1024
    buffer_load_dwordx4 v4, s[12:15], s36 offen offset:3072 nt lds
    v_mfma_f32_32x32x16_bf16 v[128:143], a[80:83], v[48:51], v[128:143]
    s_waitcnt lgkmcnt(12)
    ds_read_b64_tr_b16 a[72:73], v218 offset:2048
    ds_read_b64_tr_b16 a[74:75], v218 offset:3072
    s_waitcnt lgkmcnt(13)
    buffer_store_dwordx4 v[104:107], v11, s[16:19], s40 offen nt sc1
    v_mfma_f32_32x32x16_bf16 v[144:159], a[84:87], v[48:51], v[144:159]
    s_waitcnt lgkmcnt(11)
    ds_read_b64_tr_b16 a[76:77], v219 offset:2048
    ds_read_b64_tr_b16 a[78:79], v219 offset:3072
    v_mfma_f32_32x32x16_bf16 v[128:143], a[88:91], v[52:55], v[128:143]
    s_waitcnt lgkmcnt(10)
    ds_read_b64_tr_b16 a[80:81], v208 offset:12288
    ds_read_b64_tr_b16 a[82:83], v208 offset:13312
    s_and_b32 s56, s46, 0xd000
    s_add_u32 s56, s56, 0x12000
    v_add_u32 v218, s56, v208
    v_add_u32 v219, s56, v209
    v_mfma_f32_32x32x16_bf16 v[144:159], a[92:95], v[52:55], v[144:159]
    s_waitcnt lgkmcnt(9)
    ds_read_b64_tr_b16 a[84:85], v208 offset:14336
    ds_read_b64_tr_b16 a[86:87], v208 offset:15360
    v_mfma_f32_32x32x16_bf16 v[128:143], a[64:67], v[64:67], v[128:143]
    s_waitcnt lgkmcnt(8)
    ds_read_b64_tr_b16 a[88:89], v209 offset:12288
    ds_read_b64_tr_b16 a[90:91], v209 offset:13312
    buffer_store_dwordx4 v[108:111], v11, s[16:19], s41 offen nt sc1
    v_mfma_f32_32x32x16_bf16 v[144:159], a[68:71], v[64:67], v[144:159]
    s_waitcnt lgkmcnt(8)
    s_waitcnt vmcnt(14)
    s_barrier
    ds_read_b64_tr_b16 a[92:93], v209 offset:14336
    ds_read_b64_tr_b16 a[94:95], v209 offset:15360
    v_mfma_f32_32x32x16_bf16 v[128:143], a[72:75], v[68:71], v[128:143]
    s_waitcnt lgkmcnt(8)
    ds_read_b64_tr_b16 a[64:65], v208 offset:16384
    ds_read_b64_tr_b16 a[66:67], v208 offset:17408
    ds_write_b32 v245, v246
    v_mfma_f32_32x32x16_bf16 v[144:159], a[76:79], v[68:71], v[144:159]
    s_waitcnt lgkmcnt(9)
    ds_read_b64_tr_b16 a[68:69], v209 offset:16384
    ds_read_b64_tr_b16 a[70:71], v209 offset:17408
    v_mfma_f32_32x32x16_bf16 v[128:143], a[80:83], v[80:83], v[128:143]
    s_waitcnt lgkmcnt(9)
    ds_read_b64_tr_b16 a[72:73], v208 offset:18432
    ds_read_b64_tr_b16 a[74:75], v208 offset:19456
    buffer_store_dwordx4 v[120:123], v11, s[16:19], s42 offen nt sc1
    v_mfma_f32_32x32x16_bf16 v[128:143], a[84:87], v[84:87], v[128:143]
    s_waitcnt lgkmcnt(9)
    ds_read_b64_tr_b16 a[76:77], v209 offset:18432
    ds_read_b64_tr_b16 a[78:79], v209 offset:19456
    buffer_store_dwordx4 v[124:127], v11, s[16:19], s43 offen nt sc1
    v_mfma_f32_32x32x16_bf16 v[144:159], a[88:91], v[80:83], v[144:159]
    s_waitcnt lgkmcnt(9)
    ds_read_b64_tr_b16 a[80:81], v208 offset:20480
    ds_read_b64_tr_b16 a[82:83], v208 offset:21504
    v_mfma_f32_32x32x16_bf16 v[144:159], a[92:95], v[84:87], v[144:159]
    s_waitcnt lgkmcnt(9)
    ds_read_b64_tr_b16 a[84:85], v209 offset:20480
    ds_read_b64_tr_b16 a[86:87], v209 offset:21504
    v_mfma_f32_32x32x16_bf16 v[96:111], a[64:67], v[24:27], 0
    s_waitcnt lgkmcnt(8)
    ds_read_b64_tr_b16 a[88:89], v208 offset:22528
    ds_read_b64_tr_b16 a[90:91], v208 offset:23552
    v_mfma_f32_32x32x16_bf16 v[112:127], a[68:71], v[24:27], 0
    s_waitcnt lgkmcnt(8)
    ds_read_b64_tr_b16 a[92:93], v209 offset:22528
    ds_read_b64_tr_b16 a[94:95], v209 offset:23552
    v_mul_f32 v128, v128, v15
    v_mul_f32 v129, v129, v15
    v_mul_f32 v130, v130, v15
    v_mul_f32 v131, v131, v15
    v_mul_f32 v132, v132, v15
    v_mfma_f32_32x32x16_bf16 v[96:111], a[72:75], v[28:31], v[96:111]
    s_waitcnt lgkmcnt(8)
    ds_read_b64_tr_b16 a[64:65], v208 offset:24576
    ds_read_b64_tr_b16 a[66:67], v208 offset:25600
    v_mul_f32 v133, v133, v15
    v_mul_f32 v134, v134, v15
    v_mul_f32 v135, v135, v15
    v_cvt_pk_bf16_f32 v128, v128, v129
    v_cvt_pk_bf16_f32 v129, v130, v131
    v_mfma_f32_32x32x16_bf16 v[112:127], a[76:79], v[28:31], v[112:127]
    s_waitcnt lgkmcnt(8)
    ds_read_b64_tr_b16 a[68:69], v209 offset:24576
    ds_read_b64_tr_b16 a[70:71], v209 offset:25600
    v_cvt_pk_bf16_f32 v130, v132, v133
    v_cvt_pk_bf16_f32 v131, v134, v135
    v_mul_f32 v136, v136, v15
    v_mul_f32 v137, v137, v15
    v_mul_f32 v138, v138, v15
    v_mfma_f32_32x32x16_bf16 v[96:111], a[80:83], v[40:43], v[96:111]
    s_waitcnt lgkmcnt(8)
    ds_read_b64_tr_b16 a[72:73], v208 offset:26624
    ds_read_b64_tr_b16 a[74:75], v208 offset:27648
    ds_write_b64 v6, v[128:129]
    v_mul_f32 v139, v139, v15
    v_mul_f32 v140, v140, v15
    v_mfma_f32_32x32x16_bf16 v[112:127], a[84:87], v[40:43], v[112:127]
    s_waitcnt lgkmcnt(9)
    ds_read_b64_tr_b16 a[76:77], v209 offset:26624
    ds_read_b64_tr_b16 a[78:79], v209 offset:27648
    ds_write_b64 v6, v[130:131] offset:8
    v_mul_f32 v141, v141, v15
    v_mul_f32 v142, v142, v15
    v_mfma_f32_32x32x16_bf16 v[96:111], a[88:91], v[44:47], v[96:111]
    s_waitcnt lgkmcnt(10)
    ds_read_b64_tr_b16 a[80:81], v208 offset:28672
    ds_read_b64_tr_b16 a[82:83], v208 offset:29696
    v_mul_f32 v143, v143, v15
    v_cvt_pk_bf16_f32 v132, v136, v137
    v_cvt_pk_bf16_f32 v133, v138, v139
    v_cvt_pk_bf16_f32 v134, v140, v141
    v_cvt_pk_bf16_f32 v135, v142, v143
    v_mfma_f32_32x32x16_bf16 v[112:127], a[92:95], v[44:47], v[112:127]
    s_waitcnt lgkmcnt(10)
    ds_read_b64_tr_b16 a[84:85], v209 offset:28672
    ds_read_b64_tr_b16 a[86:87], v209 offset:29696
    ds_write_b64 v7, v[132:133]
    v_mul_f32 v144, v144, v15
    v_mul_f32 v145, v145, v15
    v_mfma_f32_32x32x16_bf16 v[96:111], a[64:67], v[56:59], v[96:111]
    s_waitcnt lgkmcnt(11)
    ds_read_b64_tr_b16 a[88:89], v208 offset:30720
    ds_read_b64_tr_b16 a[90:91], v208 offset:31744
    ds_write_b64 v7, v[134:135] offset:8
    v_mul_f32 v146, v146, v15
    v_mul_f32 v147, v147, v15
    v_mfma_f32_32x32x16_bf16 v[112:127], a[68:71], v[56:59], v[112:127]
    s_waitcnt lgkmcnt(12)
    s_waitcnt vmcnt(12)
    s_barrier
    ds_read_b64_tr_b16 a[92:93], v209 offset:30720
    ds_read_b64_tr_b16 a[94:95], v209 offset:31744
    ds_read_b128 v[248:251], v247
    v_mul_f32 v148, v148, v15
    v_mul_f32 v149, v149, v15
    v_mfma_f32_32x32x16_bf16 v[96:111], a[72:75], v[60:63], v[96:111]
    s_waitcnt lgkmcnt(12)
    ds_read_b64_tr_b16 a[64:65], v210 offset:49152
    ds_read_b64_tr_b16 a[66:67], v210 offset:50176
    v_mul_f32 v150, v150, v15
    v_mul_f32 v151, v151, v15
    v_cvt_pk_bf16_f32 v144, v144, v145
    v_cvt_pk_bf16_f32 v145, v146, v147
    v_cvt_pk_bf16_f32 v146, v148, v149
    v_mfma_f32_32x32x16_bf16 v[112:127], a[76:79], v[60:63], v[112:127]
    s_waitcnt lgkmcnt(11)
    ds_read_b64_tr_b16 a[68:69], v211 offset:49152
    ds_read_b64_tr_b16 a[70:71], v211 offset:50176
    v_cvt_pk_bf16_f32 v147, v150, v151
    v_mul_f32 v152, v152, v15
    v_mul_f32 v153, v153, v15
    v_mul_f32 v154, v154, v15
    v_mul_f32 v155, v155, v15
    v_mfma_f32_32x32x16_bf16 v[96:111], a[80:83], v[72:75], v[96:111]
    s_waitcnt lgkmcnt(11)
    ds_read_b64_tr_b16 a[72:73], v210 offset:51200
    ds_read_b64_tr_b16 a[74:75], v210 offset:52224
    ds_write_b64 v8, v[144:145]
    v_mul_f32 v156, v156, v15
    v_mul_f32 v157, v157, v15
    v_mfma_f32_32x32x16_bf16 v[112:127], a[84:87], v[72:75], v[112:127]
    s_waitcnt lgkmcnt(11)
    ds_read_b64_tr_b16 a[76:77], v211 offset:51200
    ds_read_b64_tr_b16 a[78:79], v211 offset:52224
    ds_write_b64 v8, v[146:147] offset:8
    v_mul_f32 v158, v158, v15
    v_mul_f32 v159, v159, v15
    v_mfma_f32_32x32x16_bf16 v[96:111], a[88:91], v[76:79], v[96:111]
    s_waitcnt lgkmcnt(11)
    ds_read_b64_tr_b16 a[80:81], v214
    ds_read_b64_tr_b16 a[82:83], v214 offset:1024
    v_cvt_pk_bf16_f32 v148, v152, v153
    v_cvt_pk_bf16_f32 v149, v154, v155
    v_cvt_pk_bf16_f32 v150, v156, v157
    v_cvt_pk_bf16_f32 v151, v158, v159
    v_mfma_f32_32x32x16_bf16 v[112:127], a[92:95], v[76:79], v[112:127]
    s_waitcnt lgkmcnt(10)
    ds_read_b64_tr_b16 a[84:85], v215
    ds_read_b64_tr_b16 a[86:87], v215 offset:1024
    ds_write_b64 v9, v[148:149]
    v_or3_b32 v248, v248, v249, v250
    v_or_b32 v248, v248, v251
    s_nop 0
    v_readfirstlane_b32 s47, v248
    v_mfma_f32_32x32x16_bf16 v[96:111], a[64:67], v[16:19], v[96:111]
    s_waitcnt lgkmcnt(11)
    ds_read_b64_tr_b16 a[88:89], v214 offset:2048
    ds_read_b64_tr_b16 a[90:91], v214 offset:3072
    ds_write_b64 v9, v[150:151] offset:8
    v_mfma_f32_32x32x16_bf16 v[112:127], a[68:71], v[16:19], v[112:127]
    s_waitcnt lgkmcnt(12)
    ds_read_b64_tr_b16 a[92:93], v215 offset:2048
    ds_read_b64_tr_b16 a[94:95], v215 offset:3072
    ds_read_b128 v[136:139], v10
    v_mfma_f32_32x32x16_bf16 v[96:111], a[72:75], v[20:23], v[96:111]
    s_waitcnt lgkmcnt(12)
    ds_read_b64_tr_b16 a[64:65], v216
    ds_read_b64_tr_b16 a[66:67], v216 offset:1024
    ds_read_b128 v[140:143], v10 offset:1024
    s_and_b32 s56, s44, 0x15000
    s_add_u32 s56, s56, 0xc000
    v_add_u32 v214, s56, v208
    v_add_u32 v215, s56, v209
    v_mfma_f32_32x32x16_bf16 v[112:127], a[76:79], v[20:23], v[112:127]
    s_waitcnt lgkmcnt(12)
    ds_read_b64_tr_b16 a[68:69], v217
    ds_read_b64_tr_b16 a[70:71], v217 offset:1024
    ds_read_b128 v[152:155], v10 offset:2048
    v_mfma_f32_32x32x16_bf16 v[96:111], a[80:83], v[32:35], v[96:111]
    s_waitcnt lgkmcnt(13)
    ds_read_b64_tr_b16 a[72:73], v216 offset:2048
    ds_read_b64_tr_b16 a[74:75], v216 offset:3072
    s_waitcnt lgkmcnt(14)
    ds_read_b128 v[156:159], v10 offset:3072
    v_mfma_f32_32x32x16_bf16 v[112:127], a[84:87], v[32:35], v[112:127]
    s_waitcnt lgkmcnt(13)
    ds_read_b64_tr_b16 a[76:77], v217 offset:2048
    ds_read_b64_tr_b16 a[78:79], v217 offset:3072
    v_mfma_f32_32x32x16_bf16 v[96:111], a[88:91], v[36:39], v[96:111]
    s_waitcnt lgkmcnt(12)
    ds_read_b64_tr_b16 a[80:81], v218
    ds_read_b64_tr_b16 a[82:83], v218 offset:1024
    s_waitcnt lgkmcnt(13)
    buffer_store_dwordx4 v[136:139], v11, s[16:19], s40 offen offset:128 nt sc1
    v_mfma_f32_32x32x16_bf16 v[112:127], a[92:95], v[36:39], v[112:127]
    s_waitcnt lgkmcnt(11)
    ds_read_b64_tr_b16 a[84:85], v219
    ds_read_b64_tr_b16 a[86:87], v219 offset:1024
    s_and_b32 s56, s45, 0x15000
    s_add_u32 s56, s56, 0xd000
    v_add_u32 v216, s56, v208
    v_add_u32 v217, s56, v209
    v_mfma_f32_32x32x16_bf16 v[96:111], a[64:67], v[48:51], v[96:111]
    s_waitcnt lgkmcnt(10)
    ds_read_b64_tr_b16 a[88:89], v218 offset:2048
    ds_read_b64_tr_b16 a[90:91], v218 offset:3072
    v_mfma_f32_32x32x16_bf16 v[112:127], a[68:71], v[48:51], v[112:127]
    s_waitcnt lgkmcnt(9)
    ds_read_b64_tr_b16 a[92:93], v219 offset:2048
    ds_read_b64_tr_b16 a[94:95], v219 offset:3072
    v_mfma_f32_32x32x16_bf16 v[96:111], a[72:75], v[52:55], v[96:111]
    s_waitcnt lgkmcnt(8)
    ds_read_b64_tr_b16 a[64:65], v210 offset:12288
    ds_read_b64_tr_b16 a[66:67], v210 offset:13312
    buffer_store_dwordx4 v[140:143], v11, s[16:19], s41 offen offset:128 nt sc1
    v_mfma_f32_32x32x16_bf16 v[112:127], a[76:79], v[52:55], v[112:127]
    s_waitcnt lgkmcnt(8)
    ds_read_b64_tr_b16 a[68:69], v210 offset:14336
    ds_read_b64_tr_b16 a[70:71], v210 offset:15360
    s_and_b32 s56, s46, 0x15000
    s_add_u32 s56, s56, 0xe000
    v_add_u32 v218, s56, v208
    v_add_u32 v219, s56, v209
    v_mfma_f32_32x32x16_bf16 v[96:111], a[80:83], v[64:67], v[96:111]
    s_waitcnt lgkmcnt(8)
    ds_read_b64_tr_b16 a[72:73], v211 offset:12288
    ds_read_b64_tr_b16 a[74:75], v211 offset:13312
    v_mfma_f32_32x32x16_bf16 v[112:127], a[84:87], v[64:67], v[112:127]
    s_waitcnt lgkmcnt(8)
    s_waitcnt vmcnt(10)
    s_barrier
    ds_read_b64_tr_b16 a[76:77], v211 offset:14336
    ds_read_b64_tr_b16 a[78:79], v211 offset:15360
    v_mfma_f32_32x32x16_bf16 v[96:111], a[88:91], v[68:71], v[96:111]
    s_waitcnt lgkmcnt(8)
    ds_read_b64_tr_b16 a[80:81], v208 offset:32768
    ds_read_b64_tr_b16 a[82:83], v208 offset:33792
    buffer_store_dwordx4 v[152:155], v11, s[16:19], s42 offen offset:128 nt sc1
    v_mfma_f32_32x32x16_bf16 v[112:127], a[92:95], v[68:71], v[112:127]
    s_waitcnt lgkmcnt(8)
    ds_read_b64_tr_b16 a[84:85], v208 offset:34816
    ds_read_b64_tr_b16 a[86:87], v208 offset:35840
    v_mfma_f32_32x32x16_bf16 v[96:111], a[64:67], v[80:83], v[96:111]
    s_waitcnt lgkmcnt(8)
    ds_read_b64_tr_b16 a[88:89], v208 offset:36864
    ds_read_b64_tr_b16 a[90:91], v208 offset:37888
    v_mfma_f32_32x32x16_bf16 v[96:111], a[68:71], v[84:87], v[96:111]
    s_waitcnt lgkmcnt(8)
    ds_read_b64_tr_b16 a[92:93], v208 offset:38912
    ds_read_b64_tr_b16 a[94:95], v208 offset:39936
    buffer_store_dwordx4 v[156:159], v11, s[16:19], s43 offen offset:128 nt sc1
    v_mfma_f32_32x32x16_bf16 v[112:127], a[72:75], v[80:83], v[112:127]
    s_waitcnt lgkmcnt(8)
    ds_read_b64_tr_b16 a[64:65], v208 offset:40960
    ds_read_b64_tr_b16 a[66:67], v208 offset:41984
    v_mfma_f32_32x32x16_bf16 v[112:127], a[76:79], v[84:87], v[112:127]
    s_waitcnt lgkmcnt(8)
    ds_read_b64_tr_b16 a[68:69], v208 offset:43008
    ds_read_b64_tr_b16 a[70:71], v208 offset:44032
    v_mfma_f32_32x32x16_bf16 v[128:143], a[80:83], v[24:27], 0
    s_waitcnt lgkmcnt(8)
    ds_read_b64_tr_b16 a[72:73], v208 offset:45056
    ds_read_b64_tr_b16 a[74:75], v208 offset:46080
    v_mfma_f32_32x32x16_bf16 v[128:143], a[84:87], v[28:31], v[128:143]
    s_waitcnt lgkmcnt(8)
    s_waitcnt vmcnt(8)
    s_barrier
    ds_read_b64_tr_b16 a[76:77], v208 offset:47104
    ds_read_b64_tr_b16 a[78:79], v208 offset:48128
    v_mul_f32 v96, v96, v15
    v_mul_f32 v97, v97, v15
    v_mul_f32 v98, v98, v15
    v_mfma_f32_32x32x16_bf16 v[128:143], a[88:91], v[40:43], v[128:143]
    s_waitcnt lgkmcnt(8)
    ds_read_b64_tr_b16 a[80:81], v212
    ds_read_b64_tr_b16 a[82:83], v212 offset:1024
    v_mul_f32 v99, v99, v15
    v_mul_f32 v100, v100, v15
    v_mul_f32 v101, v101, v15
    v_mul_f32 v102, v102, v15
    v_mul_f32 v103, v103, v15
    v_mfma_f32_32x32x16_bf16 v[128:143], a[92:95], v[44:47], v[128:143]
    s_waitcnt lgkmcnt(8)
    ds_read_b64_tr_b16 a[84:85], v212 offset:2048
    ds_read_b64_tr_b16 a[86:87], v212 offset:3072
    v_cvt_pk_bf16_f32 v96, v96, v97
    v_cvt_pk_bf16_f32 v97, v98, v99
    v_cvt_pk_bf16_f32 v98, v100, v101
    v_cvt_pk_bf16_f32 v99, v102, v103
    v_mul_f32 v104, v104, v15
    v_mfma_f32_32x32x16_bf16 v[128:143], a[64:67], v[56:59], v[128:143]
    s_waitcnt lgkmcnt(8)
    ds_read_b64_tr_b16 a[88:89], v214
    ds_read_b64_tr_b16 a[90:91], v214 offset:1024
    ds_write_b64 v6, v[96:97]
    v_mul_f32 v105, v105, v15
    v_mul_f32 v106, v106, v15
    v_mfma_f32_32x32x16_bf16 v[128:143], a[68:71], v[60:63], v[128:143]
    s_waitcnt lgkmcnt(9)
    ds_read_b64_tr_b16 a[92:93], v214 offset:2048
    ds_read_b64_tr_b16 a[94:95], v214 offset:3072
    ds_write_b64 v6, v[98:99] offset:8
    v_mul_f32 v107, v107, v15
    v_mul_f32 v108, v108, v15
    v_mfma_f32_32x32x16_bf16 v[128:143], a[72:75], v[72:75], v[128:143]
    s_waitcnt lgkmcnt(10)
    ds_read_b64_tr_b16 a[64:65], v216
    ds_read_b64_tr_b16 a[66:67], v216 offset:1024
    v_mul_f32 v109, v109, v15
    v_mul_f32 v110, v110, v15
    v_mul_f32 v111, v111, v15
    v_cvt_pk_bf16_f32 v100, v104, v105
    v_cvt_pk_bf16_f32 v101, v106, v107
    v_mfma_f32_32x32x16_bf16 v[128:143], a[76:79], v[76:79], v[128:143]
    s_waitcnt lgkmcnt(10)
    ds_read_b64_tr_b16 a[68:69], v216 offset:2048
    ds_read_b64_tr_b16 a[70:71], v216 offset:3072
    v_cvt_pk_bf16_f32 v102, v108, v109
    v_cvt_pk_bf16_f32 v103, v110, v111
    v_mul_f32 v112, v112, v15
    v_mul_f32 v113, v113, v15
    v_mul_f32 v114, v114, v15
    v_mfma_f32_32x32x16_bf16 v[128:143], a[80:83], v[16:19], v[128:143]
    s_waitcnt lgkmcnt(10)
    ds_read_b64_tr_b16 a[72:73], v218
    ds_read_b64_tr_b16 a[74:75], v218 offset:1024
    ds_write_b64 v7, v[100:101]
    v_mul_f32 v115, v115, v15
    v_mul_f32 v116, v116, v15
    v_mfma_f32_32x32x16_bf16 v[128:143], a[84:87], v[20:23], v[128:143]
    s_waitcnt lgkmcnt(11)
    ds_read_b64_tr_b16 a[76:77], v218 offset:2048
    ds_read_b64_tr_b16 a[78:79], v218 offset:3072
    ds_write_b64 v7, v[102:103] offset:8
    v_mul_f32 v117, v117, v15
    v_mul_f32 v118, v118, v15
    v_mfma_f32_32x32x16_bf16 v[128:143], a[88:91], v[32:35], v[128:143]
    s_waitcnt lgkmcnt(11)
    ds_read_b64_tr_b16 a[80:81], v208 offset:61440
    ds_read_b64_tr_b16 a[82:83], v208 offset:62464
    v_mul_f32 v119, v119, v15
    v_cvt_pk_bf16_f32 v112, v112, v113
    v_cvt_pk_bf16_f32 v113, v114, v115
    v_cvt_pk_bf16_f32 v114, v116, v117
    v_cvt_pk_bf16_f32 v115, v118, v119
    v_mfma_f32_32x32x16_bf16 v[128:143], a[92:95], v[36:39], v[128:143]
    s_waitcnt lgkmcnt(10)
    ds_read_b64_tr_b16 a[84:85], v208 offset:63488
    ds_read_b64_tr_b16 a[86:87], v208 offset:64512
    ds_write_b64 v8, v[112:113]
    v_mul_f32 v120, v120, v15
    v_mul_f32 v121, v121, v15
    v_mfma_f32_32x32x16_bf16 v[128:143], a[64:67], v[48:51], v[128:143]
    s_waitcnt lgkmcnt(11)
    ds_read_b64_tr_b16 a[88:89], v209 offset:32768
    ds_read_b64_tr_b16 a[90:91], v209 offset:33792
    ds_write_b64 v8, v[114:115] offset:8
    v_mul_f32 v122, v122, v15
    v_mul_f32 v123, v123, v15
    v_mfma_f32_32x32x16_bf16 v[128:143], a[68:71], v[52:55], v[128:143]
    s_waitcnt lgkmcnt(12)
    ds_read_b64_tr_b16 a[92:93], v209 offset:34816
    ds_read_b64_tr_b16 a[94:95], v209 offset:35840
    v_mul_f32 v124, v124, v15
    v_mul_f32 v125, v125, v15
    v_mul_f32 v126, v126, v15
    v_mul_f32 v127, v127, v15
    v_cvt_pk_bf16_f32 v116, v120, v121
    v_mfma_f32_32x32x16_bf16 v[128:143], a[72:75], v[64:67], v[128:143]
    s_waitcnt lgkmcnt(11)
    ds_read_b64_tr_b16 a[64:65], v209 offset:36864
    ds_read_b64_tr_b16 a[66:67], v209 offset:37888
    v_cvt_pk_bf16_f32 v117, v122, v123
    v_cvt_pk_bf16_f32 v118, v124, v125
    v_cvt_pk_bf16_f32 v119, v126, v127
    v_mfma_f32_32x32x16_bf16 v[128:143], a[76:79], v[68:71], v[128:143]
    s_waitcnt lgkmcnt(10)
    ds_read_b64_tr_b16 a[68:69], v209 offset:38912
    ds_read_b64_tr_b16 a[70:71], v209 offset:39936
    ds_write_b64 v9, v[116:117]
    v_mfma_f32_32x32x16_bf16 v[128:143], a[80:83], v[80:83], v[128:143]
    s_waitcnt lgkmcnt(11)
    ds_read_b64_tr_b16 a[72:73], v209 offset:40960
    ds_read_b64_tr_b16 a[74:75], v209 offset:41984
    ds_write_b64 v9, v[118:119] offset:8
    v_mfma_f32_32x32x16_bf16 v[128:143], a[84:87], v[84:87], v[128:143]
    s_waitcnt lgkmcnt(11)
    ds_read_b64_tr_b16 a[76:77], v209 offset:43008
    ds_read_b64_tr_b16 a[78:79], v209 offset:44032
    ds_read_b128 v[104:107], v10
    v_mfma_f32_32x32x16_bf16 v[144:159], a[88:91], v[24:27], 0
    s_waitcnt lgkmcnt(11)
    ds_read_b64_tr_b16 a[80:81], v209 offset:45056
    ds_read_b64_tr_b16 a[82:83], v209 offset:46080
    ds_read_b128 v[108:111], v10 offset:1024
    v_mfma_f32_32x32x16_bf16 v[144:159], a[92:95], v[28:31], v[144:159]
    s_waitcnt lgkmcnt(12)
    ds_read_b64_tr_b16 a[84:85], v209 offset:47104
    ds_read_b64_tr_b16 a[86:87], v209 offset:48128
    ds_read_b128 v[120:123], v10 offset:2048
    v_mul_f32 v128, v128, v15
    v_mul_f32 v129, v129, v15
    v_mul_f32 v130, v130, v15
    v_mul_f32 v131, v131, v15
    v_mfma_f32_32x32x16_bf16 v[144:159], a[64:67], v[40:43], v[144:159]
    s_waitcnt lgkmcnt(13)
    ds_read_b64_tr_b16 a[88:89], v213
    ds_read_b64_tr_b16 a[90:91], v213 offset:1024
    s_waitcnt lgkmcnt(14)
    ds_read_b128 v[124:127], v10 offset:3072
    v_mul_f32 v132, v132, v15
    v_mul_f32 v133, v133, v15
    v_mul_f32 v134, v134, v15
    v_mul_f32 v135, v135, v15
    v_mfma_f32_32x32x16_bf16 v[144:159], a[68:71], v[44:47], v[144:159]
    s_waitcnt lgkmcnt(13)
    ds_read_b64_tr_b16 a[92:93], v213 offset:2048
    ds_read_b64_tr_b16 a[94:95], v213 offset:3072
    v_cvt_pk_bf16_f32 v128, v128, v129
    v_cvt_pk_bf16_f32 v129, v130, v131
    v_cvt_pk_bf16_f32 v130, v132, v133
    v_cvt_pk_bf16_f32 v131, v134, v135
    v_mul_f32 v136, v136, v15
    v_mfma_f32_32x32x16_bf16 v[144:159], a[72:75], v[56:59], v[144:159]
    s_waitcnt lgkmcnt(12)
    ds_read_b64_tr_b16 a[64:65], v215
    ds_read_b64_tr_b16 a[66:67], v215 offset:1024
    s_waitcnt lgkmcnt(13)
    buffer_store_dwordx4 v[104:107], v11, s[16:19], s40 offen offset:256 nt sc1
    v_mul_f32 v137, v137, v15
    v_mul_f32 v138, v138, v15
    v_mfma_f32_32x32x16_bf16 v[144:159], a[76:79], v[60:63], v[144:159]
    s_waitcnt lgkmcnt(11)
    ds_read_b64_tr_b16 a[68:69], v215 offset:2048
    ds_read_b64_tr_b16 a[70:71], v215 offset:3072
    v_mul_f32 v139, v139, v15
    v_mul_f32 v140, v140, v15
    v_mul_f32 v141, v141, v15
    v_mul_f32 v142, v142, v15
    v_mul_f32 v143, v143, v15
    v_mfma_f32_32x32x16_bf16 v[144:159], a[80:83], v[72:75], v[144:159]
    s_waitcnt lgkmcnt(10)
    ds_read_b64_tr_b16 a[72:73], v217
    ds_read_b64_tr_b16 a[74:75], v217 offset:1024
    v_cvt_pk_bf16_f32 v132, v136, v137
    v_cvt_pk_bf16_f32 v133, v138, v139
    v_cvt_pk_bf16_f32 v134, v140, v141
    v_cvt_pk_bf16_f32 v135, v142, v143
    v_mfma_f32_32x32x16_bf16 v[144:159], a[84:87], v[76:79], v[144:159]
    s_waitcnt lgkmcnt(9)
    ds_read_b64_tr_b16 a[76:77], v217 offset:2048
    ds_read_b64_tr_b16 a[78:79], v217 offset:3072
    v_mfma_f32_32x32x16_bf16 v[144:159], a[88:91], v[16:19], v[144:159]
    s_waitcnt lgkmcnt(8)
    ds_read_b64_tr_b16 a[80:81], v219
    ds_read_b64_tr_b16 a[82:83], v219 offset:1024
    buffer_store_dwordx4 v[108:111], v11, s[16:19], s41 offen offset:256 nt sc1
    v_mfma_f32_32x32x16_bf16 v[144:159], a[92:95], v[20:23], v[144:159]
    s_waitcnt lgkmcnt(8)
    ds_read_b64_tr_b16 a[84:85], v219 offset:2048
    ds_read_b64_tr_b16 a[86:87], v219 offset:3072
    v_mfma_f32_32x32x16_bf16 v[144:159], a[64:67], v[32:35], v[144:159]
    s_waitcnt lgkmcnt(8)
    ds_read_b64_tr_b16 a[88:89], v209 offset:61440
    ds_read_b64_tr_b16 a[90:91], v209 offset:62464
    v_mfma_f32_32x32x16_bf16 v[144:159], a[68:71], v[36:39], v[144:159]
    s_waitcnt lgkmcnt(8)
    ds_read_b64_tr_b16 a[92:93], v209 offset:63488
    ds_read_b64_tr_b16 a[94:95], v209 offset:64512
    buffer_store_dwordx4 v[120:123], v11, s[16:19], s42 offen offset:256 nt sc1
    buffer_store_dwordx4 v[124:127], v11, s[16:19], s43 offen offset:256 nt sc1
    v_mfma_f32_32x32x16_bf16 v[144:159], a[72:75], v[48:51], v[144:159]
    s_waitcnt lgkmcnt(8)
    ds_write_b64 v6, v[128:129]
    v_mfma_f32_32x32x16_bf16 v[144:159], a[76:79], v[52:55], v[144:159]
    s_waitcnt lgkmcnt(7)
    ds_write_b64 v6, v[130:131] offset:8
    v_mfma_f32_32x32x16_bf16 v[144:159], a[80:83], v[64:67], v[144:159]
    s_waitcnt lgkmcnt(6)
    ds_write_b64 v7, v[132:133]
    v_mfma_f32_32x32x16_bf16 v[144:159], a[84:87], v[68:71], v[144:159]
    s_waitcnt lgkmcnt(5)
    ds_write_b64 v7, v[134:135] offset:8
    v_mfma_f32_32x32x16_bf16 v[144:159], a[88:91], v[80:83], v[144:159]
    s_waitcnt lgkmcnt(4)
    v_mfma_f32_32x32x16_bf16 v[144:159], a[92:95], v[84:87], v[144:159]
    s_nop 11
    v_mul_f32 v144, v144, v15
    v_mul_f32 v145, v145, v15
    v_mul_f32 v146, v146, v15
    v_mul_f32 v147, v147, v15
    v_mul_f32 v148, v148, v15
    v_mul_f32 v149, v149, v15
    v_mul_f32 v150, v150, v15
    v_mul_f32 v151, v151, v15
    v_cvt_pk_bf16_f32 v144, v144, v145
    v_cvt_pk_bf16_f32 v145, v146, v147
    v_cvt_pk_bf16_f32 v146, v148, v149
    v_cvt_pk_bf16_f32 v147, v150, v151
    ds_write_b128 v8, v[144:147]
    v_mul_f32 v152, v152, v15
    v_mul_f32 v153, v153, v15
    v_mul_f32 v154, v154, v15
    v_mul_f32 v155, v155, v15
    v_mul_f32 v156, v156, v15
    v_mul_f32 v157, v157, v15
    v_mul_f32 v158, v158, v15
    v_mul_f32 v159, v159, v15
    v_cvt_pk_bf16_f32 v148, v152, v153
    v_cvt_pk_bf16_f32 v149, v154, v155
    v_cvt_pk_bf16_f32 v150, v156, v157
    v_cvt_pk_bf16_f32 v151, v158, v159
    ds_write_b128 v9, v[148:151]
    ds_read_b128 v[136:139], v10
    ds_read_b128 v[140:143], v10 offset:1024
    ds_read_b128 v[152:155], v10 offset:2048
    ds_read_b128 v[156:159], v10 offset:3072
    s_waitcnt lgkmcnt(3)
    buffer_store_dwordx4 v[136:139], v11, s[16:19], s40 offen offset:384 nt sc1
    s_waitcnt lgkmcnt(2)
    buffer_store_dwordx4 v[140:143], v11, s[16:19], s41 offen offset:384 nt sc1
    s_waitcnt lgkmcnt(1)
    buffer_store_dwordx4 v[152:155], v11, s[16:19], s42 offen offset:384 nt sc1
    s_waitcnt lgkmcnt(0)
    buffer_store_dwordx4 v[156:159], v11, s[16:19], s43 offen offset:384 nt sc1
    s_cmp_lg_u32 s47, 0
    s_cbranch_scc1 L_fallback
    s_endpgm
L_fallback:
    s_waitcnt vmcnt(0) lgkmcnt(0)
    s_nop 15
    s_barrier
    s_lshl_b32 s52, s20, 6
    s_nop 3
    v_or_b32 v0, s52, v0
    s_nop 3
    s_cmp_ge_u32 s2, 256
    s_cbranch_scc1 L_end
    s_load_dwordx4 s[64:67], s[0:1], 0
    s_load_dwordx2 s[68:69], s[0:1], 16
    s_load_dwordx2 s[70:71], s[0:1], 32
    v_lshrrev_b32 v199, 6, v0
    v_and_b32 v0, 63, v0
    v_readfirstlane_b32 s20, v199
    s_and_b32 s52, s2, 7
    s_lshr_b32 s53, s2, 3
    s_and_b32 s21, s53, 15
    s_lshr_b32 s53, s53, 4
    s_lshl_b32 s52, s52, 1
    s_add_u32 s22, s52, s53
    s_lshl_b32 s22, s22, 20
    v_lshrrev_b32 v196, 5, v0
    v_and_b32 v197, 31, v0
    v_xor_b32 v198, v197, v196
    v_lshlrev_b32 v198, 4, v198
    v_lshlrev_b32 v199, 9, v196
    v_or_b32 v198, v199, v198
    v_xor_b32 v180, 0, v198
    v_xor_b32 v184, 0x80, v198
    v_xor_b32 v181, 32, v198
    v_xor_b32 v185, 0xa0, v198
    v_xor_b32 v182, 64, v198
    v_xor_b32 v186, 0xc0, v198
    v_xor_b32 v183, 0x60, v198
    v_xor_b32 v187, 0xe0, v198
    s_lshl_b32 s23, s20, 12
    s_lshl_b32 s36, s20, 11
    s_lshl_b32 s37, s20, 10
    s_and_b32 s52, s20, 1
    s_lshl_b32 s52, s52, 7
    v_xor_b32 v176, s52, v180
    v_xor_b32 v177, s52, v181
    v_xor_b32 v178, s52, v182
    v_xor_b32 v179, s52, v183
    s_lshl_b32 s53, s21, 16
    s_lshl_b32 s54, s20, 14
    s_add_u32 s55, s53, s54
    s_add_u32 s40, s55, 0
    s_add_u32 s41, s55, 0x1000
    s_add_u32 s42, s55, 0x2000
    s_add_u32 s43, s55, 0x3000
    s_add_u32 s56, s53, s23
    s_add_u32 s24, s56, 0xfffe0000
    s_cmp_ge_u32 s21, 2
    s_cselect_b32 s24, s24, 0x40000000
    s_add_u32 s25, s56, 0xfffe4000
    s_cmp_ge_u32 s21, 2
    s_cselect_b32 s25, s25, 0x40000000
    s_add_u32 s26, s56, 0xfffe8000
    s_cmp_ge_u32 s21, 2
    s_cselect_b32 s26, s26, 0x40000000
    s_add_u32 s27, s56, 0xfffec000
    s_cmp_ge_u32 s21, 2
    s_cselect_b32 s27, s27, 0x40000000
    s_add_u32 s28, s56, 0xffff0000
    s_cmp_ge_u32 s21, 1
    s_cselect_b32 s28, s28, 0x40000000
    s_add_u32 s29, s56, 0xffff4000
    s_cmp_ge_u32 s21, 1
    s_cselect_b32 s29, s29, 0x40000000
    s_add_u32 s30, s56, 0xffff8000
    s_cmp_ge_u32 s21, 1
    s_cselect_b32 s30, s30, 0x40000000
    s_add_u32 s31, s56, 0xffffc000
    s_cmp_ge_u32 s21, 1
    s_cselect_b32 s31, s31, 0x40000000
    s_add_u32 s32, s56, 0
    s_add_u32 s33, s56, 0x4000
    s_add_u32 s34, s56, 0x8000
    s_add_u32 s35, s56, 0xc000
    s_waitcnt lgkmcnt(0)
    s_add_u32 s4, s64, s22
    s_addc_u32 s5, s65, 0
    s_mov_b32 s6, 0x100000
    s_mov_b32 s7, 0x20000
    s_add_u32 s8, s66, s22
    s_addc_u32 s9, s67, 0
    s_mov_b32 s10, 0x100000
    s_mov_b32 s11, 0x20000
    s_add_u32 s12, s68, s22
    s_addc_u32 s13, s69, 0
    s_mov_b32 s14, 0x100000
    s_mov_b32 s15, 0x20000
    s_add_u32 s16, s70, s22
    s_addc_u32 s17, s71, 0
    s_mov_b32 s18, 0x100000
    s_mov_b32 s19, 0x20000
    s_lshl_b32 s57, s20, 14
    s_add_u32 s57, s57, 0x18000
    s_add_u32 m0, s57, 0
    s_mov_b32 s52, s40
    buffer_load_dwordx4 v180, s[4:7], s52 offen nt lds
    buffer_load_dwordx4 v181, s[4:7], s52 offen offset:1024 nt lds
    buffer_load_dwordx4 v182, s[4:7], s52 offen offset:2048 nt lds
    buffer_load_dwordx4 v183, s[4:7], s52 offen offset:3072 nt lds
    s_add_u32 m0, s57, 0x1000
    s_mov_b32 s52, s41
    buffer_load_dwordx4 v184, s[4:7], s52 offen nt lds
    buffer_load_dwordx4 v185, s[4:7], s52 offen offset:1024 nt lds
    buffer_load_dwordx4 v186, s[4:7], s52 offen offset:2048 nt lds
    buffer_load_dwordx4 v187, s[4:7], s52 offen offset:3072 nt lds
    s_add_u32 m0, s57, 0x2000
    s_mov_b32 s52, s42
    buffer_load_dwordx4 v180, s[4:7], s52 offen nt lds
    buffer_load_dwordx4 v181, s[4:7], s52 offen offset:1024 nt lds
    buffer_load_dwordx4 v182, s[4:7], s52 offen offset:2048 nt lds
    buffer_load_dwordx4 v183, s[4:7], s52 offen offset:3072 nt lds
    s_add_u32 m0, s57, 0x3000
    s_mov_b32 s52, s43
    buffer_load_dwordx4 v184, s[4:7], s52 offen nt lds
    buffer_load_dwordx4 v185, s[4:7], s52 offen offset:1024 nt lds
    buffer_load_dwordx4 v186, s[4:7], s52 offen offset:2048 nt lds
    buffer_load_dwordx4 v187, s[4:7], s52 offen offset:3072 nt lds
    s_add_u32 m0, s23, 0
    s_nop 0
    buffer_load_dwordx4 v176, s[8:11], s28 offen nt lds
    buffer_load_dwordx4 v177, s[8:11], s28 offen offset:1024 nt lds
    buffer_load_dwordx4 v178, s[8:11], s28 offen offset:2048 nt lds
    buffer_load_dwordx4 v179, s[8:11], s28 offen offset:3072 nt lds
    s_add_u32 m0, s23, 0x4000
    s_nop 0
    buffer_load_dwordx4 v176, s[8:11], s32 offen nt lds
    buffer_load_dwordx4 v177, s[8:11], s32 offen offset:1024 nt lds
    buffer_load_dwordx4 v178, s[8:11], s32 offen offset:2048 nt lds
    buffer_load_dwordx4 v179, s[8:11], s32 offen offset:3072 nt lds
    s_add_u32 m0, s23, 0x8000
    s_nop 0
    buffer_load_dwordx4 v176, s[8:11], s24 offen nt lds
    buffer_load_dwordx4 v177, s[8:11], s24 offen offset:1024 nt lds
    buffer_load_dwordx4 v178, s[8:11], s24 offen offset:2048 nt lds
    buffer_load_dwordx4 v179, s[8:11], s24 offen offset:3072 nt lds
    s_add_u32 m0, s23, 0xc000
    s_nop 0
    buffer_load_dwordx4 v176, s[8:11], s33 offen nt lds
    buffer_load_dwordx4 v177, s[8:11], s33 offen offset:1024 nt lds
    buffer_load_dwordx4 v178, s[8:11], s33 offen offset:2048 nt lds
    buffer_load_dwordx4 v179, s[8:11], s33 offen offset:3072 nt lds
    s_add_u32 m0, s23, 0x10000
    s_nop 0
    buffer_load_dwordx4 v176, s[8:11], s29 offen nt lds
    buffer_load_dwordx4 v177, s[8:11], s29 offen offset:1024 nt lds
    buffer_load_dwordx4 v178, s[8:11], s29 offen offset:2048 nt lds
    buffer_load_dwordx4 v179, s[8:11], s29 offen offset:3072 nt lds
    s_add_u32 m0, s23, 0x14000
    s_nop 0
    buffer_load_dwordx4 v176, s[8:11], s25 offen nt lds
    buffer_load_dwordx4 v177, s[8:11], s25 offen offset:1024 nt lds
    buffer_load_dwordx4 v178, s[8:11], s25 offen offset:2048 nt lds
    buffer_load_dwordx4 v179, s[8:11], s25 offen offset:3072 nt lds
    s_mov_b32 s48, 0x3db8aa3b
    s_mov_b32 s49, 0xbdb8aa3b
    s_mov_b32 s50, 0xf1800000
    s_mov_b32 s51, 0xd3800000
    s_cmp_gt_u32 s20, 0
    s_cselect_b32 s44, -1, 0
    s_cmp_gt_u32 s20, 1
    s_cselect_b32 s45, -1, 0
    s_cmp_gt_u32 s20, 2
    s_cselect_b32 s46, -1, 0
    v_and_b32 v199, 15, v197
    v_xor_b32 v199, v199, v196
    v_lshlrev_b32 v199, 4, v199
    v_lshlrev_b32 v200, 9, v197
    v_or_b32 v199, v199, v200
    v_xor_b32 v160, 0, v199
    v_xor_b32 v161, 32, v199
    v_xor_b32 v162, 64, v199
    v_xor_b32 v163, 0x60, v199
    v_xor_b32 v164, 0x80, v199
    v_xor_b32 v165, 0xa0, v199
    v_xor_b32 v166, 0xc0, v199
    v_xor_b32 v167, 0xe0, v199
    v_lshrrev_b32 v202, 2, v0
    v_and_b32 v202, 3, v202
    v_lshrrev_b32 v203, 4, v0
    v_and_b32 v203, 1, v203
    v_and_b32 v204, 3, v0
    v_lshlrev_b32 v199, 5, v203
    v_and_b32 v200, 1, v204
    v_lshlrev_b32 v200, 4, v200
    v_or_b32 v199, v199, v200
    v_lshrrev_b32 v200, 1, v204
    v_lshlrev_b32 v200, 3, v200
    v_or_b32 v199, v199, v200
    v_lshlrev_b32 v200, 2, v196
    v_or_b32 v200, v200, v202
    v_lshlrev_b32 v201, 8, v200
    v_or_b32 v201, v201, v199
    v_lshlrev_b32 v198, 6, v202
    v_or_b32 v201, v201, v198
    v_xor_b32 v246, 0, v201
    v_xor_b32 v247, 64, v201
    v_xor_b32 v248, 0x80, v201
    v_xor_b32 v249, 0xc0, v201
    v_lshlrev_b32 v201, 7, v200
    v_or_b32 v201, v201, v199
    v_lshrrev_b32 v198, 1, v202
    v_lshlrev_b32 v198, 6, v198
    v_or_b32 v201, v201, v198
    v_xor_b32 v250, 0, v201
    v_xor_b32 v251, 64, v201
    v_lshrrev_b32 v199, 4, v0
    v_and_b32 v200, 15, v0
    v_lshlrev_b32 v201, 2, v199
    v_xor_b32 v200, v200, v201
    v_lshlrev_b32 v200, 4, v200
    v_lshlrev_b32 v199, 9, v199
    v_or_b32 v1, v199, v200
    v_add_u32 v2, 0x400, v1
    v_lshrrev_b32 v199, 3, v0
    v_lshlrev_b32 v199, 9, v199
    v_and_b32 v200, 7, v0
    v_lshlrev_b32 v201, 2, v203
    v_xor_b32 v200, v200, v201
    v_lshlrev_b32 v200, 4, v200
    v_or_b32 v5, v199, v200
    v_add_u32 v5, 0x100, v5
    v_and_b32 v199, 7, v197
    v_xor_b32 v199, v199, v196
    v_lshlrev_b32 v199, 4, v199
    v_lshlrev_b32 v200, 7, v197
    v_or_b32 v199, v199, v200
    s_add_u32 s52, s23, 0x24000
    v_add_u32 v199, s52, v199
    v_xor_b32 v6, 0, v199
    v_xor_b32 v7, 32, v199
    v_xor_b32 v8, 64, v199
    v_xor_b32 v9, 0x60, v199
    v_lshrrev_b32 v199, 3, v0
    v_and_b32 v200, 7, v0
    v_xor_b32 v201, v200, v199
    v_lshlrev_b32 v201, 4, v201
    v_lshlrev_b32 v198, 7, v199
    v_or_b32 v201, v201, v198
    v_add_u32 v10, s52, v201
    v_lshlrev_b32 v199, 9, v199
    v_lshlrev_b32 v200, 4, v200
    v_or_b32 v11, v199, v200
    v_lshlrev_b32 v199, 2, v196
    v_sub_u32 v199, v197, v199
    v_cmp_ge_i32 s[64:65], v199, 0
    v_cmp_ge_i32 s[66:67], v199, 1
    v_cmp_ge_i32 s[68:69], v199, 2
    v_cmp_ge_i32 s[70:71], v199, 3
    v_cmp_ge_i32 s[72:73], v199, 8
    v_cmp_ge_i32 s[74:75], v199, 9
    v_cmp_ge_i32 s[76:77], v199, 10
    v_cmp_ge_i32 s[78:79], v199, 11
    v_cmp_ge_i32 s[80:81], v199, 16
    v_cmp_ge_i32 s[82:83], v199, 17
    v_cmp_ge_i32 s[84:85], v199, 18
    v_cmp_ge_i32 s[86:87], v199, 19
    v_cmp_ge_i32 s[88:89], v199, 24
    v_cmp_ge_i32 s[90:91], v199, 25
    v_cmp_ge_i32 s[92:93], v199, 26
    v_cmp_ge_i32 s[94:95], v199, 27
    s_lshl_b32 s57, s21, 2
    s_add_u32 s56, s20, 8
    s_mov_b32 s52, 4
    s_add_u32 s53, s52, s57
    s_cmp_lt_u32 s53, 8
    s_cselect_b32 s54, s50, 0
    v_mov_b32 v16, s54
    v_mov_b32 v17, s54
    v_mov_b32 v18, s54
    v_mov_b32 v19, s54
    v_mov_b32 v20, s54
    v_mov_b32 v21, s54
    v_mov_b32 v22, s54
    v_mov_b32 v23, s54
    v_mov_b32 v24, s54
    v_mov_b32 v25, s54
    v_mov_b32 v26, s54
    v_mov_b32 v27, s54
    v_mov_b32 v28, s54
    v_mov_b32 v29, s54
    v_mov_b32 v30, s54
    v_mov_b32 v31, s54
    s_mov_b32 s52, 8
    s_add_u32 s53, s52, s57
    s_cmp_lt_u32 s53, 8
    s_cselect_b32 s54, s50, 0
    s_cmp_eq_u32 s52, s56
    s_cselect_b32 s53, s50, s54
    s_cmp_eq_u32 s52, s20
    s_cselect_b32 s55, s50, s54
    v_mov_b32 v205, s53
    v_mov_b32 v206, s55
    v_cndmask_b32 v32, v205, v206, s[64:65]
    v_cndmask_b32 v33, v205, v206, s[66:67]
    v_cndmask_b32 v34, v205, v206, s[68:69]
    v_cndmask_b32 v35, v205, v206, s[70:71]
    v_cndmask_b32 v36, v205, v206, s[72:73]
    v_cndmask_b32 v37, v205, v206, s[74:75]
    v_cndmask_b32 v38, v205, v206, s[76:77]
    v_cndmask_b32 v39, v205, v206, s[78:79]
    v_cndmask_b32 v40, v205, v206, s[80:81]
    v_cndmask_b32 v41, v205, v206, s[82:83]
    v_cndmask_b32 v42, v205, v206, s[84:85]
    v_cndmask_b32 v43, v205, v206, s[86:87]
    v_cndmask_b32 v44, v205, v206, s[88:89]
    v_cndmask_b32 v45, v205, v206, s[90:91]
    v_cndmask_b32 v46, v205, v206, s[92:93]
    v_cndmask_b32 v47, v205, v206, s[94:95]
    s_cmp_gt_u32 s20, 0
    s_cselect_b32 s52, 9, 0
    s_add_u32 s53, s52, s57
    s_cmp_lt_u32 s53, 8
    s_cselect_b32 s54, s50, 0
    s_cmp_eq_u32 s52, s56
    s_cselect_b32 s53, s50, s54
    s_cmp_eq_u32 s52, s20
    s_cselect_b32 s55, s50, s54
    v_mov_b32 v205, s53
    v_mov_b32 v206, s55
    v_cndmask_b32 v48, v205, v206, s[64:65]
    v_cndmask_b32 v49, v205, v206, s[66:67]
    v_cndmask_b32 v50, v205, v206, s[68:69]
    v_cndmask_b32 v51, v205, v206, s[70:71]
    v_cndmask_b32 v52, v205, v206, s[72:73]
    v_cndmask_b32 v53, v205, v206, s[74:75]
    v_cndmask_b32 v54, v205, v206, s[76:77]
    v_cndmask_b32 v55, v205, v206, s[78:79]
    v_cndmask_b32 v56, v205, v206, s[80:81]
    v_cndmask_b32 v57, v205, v206, s[82:83]
    v_cndmask_b32 v58, v205, v206, s[84:85]
    v_cndmask_b32 v59, v205, v206, s[86:87]
    v_cndmask_b32 v60, v205, v206, s[88:89]
    v_cndmask_b32 v61, v205, v206, s[90:91]
    v_cndmask_b32 v62, v205, v206, s[92:93]
    v_cndmask_b32 v63, v205, v206, s[94:95]
    s_mov_b32 s52, 5
    s_add_u32 s53, s52, s57
    s_cmp_lt_u32 s53, 8
    s_cselect_b32 s54, s50, 0
    v_mov_b32 v64, s54
    v_mov_b32 v65, s54
    v_mov_b32 v66, s54
    v_mov_b32 v67, s54
    v_mov_b32 v68, s54
    v_mov_b32 v69, s54
    v_mov_b32 v70, s54
    v_mov_b32 v71, s54
    v_mov_b32 v72, s54
    v_mov_b32 v73, s54
    v_mov_b32 v74, s54
    v_mov_b32 v75, s54
    v_mov_b32 v76, s54
    v_mov_b32 v77, s54
    v_mov_b32 v78, s54
    v_mov_b32 v79, s54
    s_cmp_gt_u32 s20, 1
    s_cselect_b32 s52, 10, 1
    s_add_u32 s53, s52, s57
    s_cmp_lt_u32 s53, 8
    s_cselect_b32 s54, s50, 0
    s_cmp_eq_u32 s52, s56
    s_cselect_b32 s53, s50, s54
    s_cmp_eq_u32 s52, s20
    s_cselect_b32 s55, s50, s54
    v_mov_b32 v205, s53
    v_mov_b32 v206, s55
    v_cndmask_b32 v80, v205, v206, s[64:65]
    v_cndmask_b32 v81, v205, v206, s[66:67]
    v_cndmask_b32 v82, v205, v206, s[68:69]
    v_cndmask_b32 v83, v205, v206, s[70:71]
    v_cndmask_b32 v84, v205, v206, s[72:73]
    v_cndmask_b32 v85, v205, v206, s[74:75]
    v_cndmask_b32 v86, v205, v206, s[76:77]
    v_cndmask_b32 v87, v205, v206, s[78:79]
    v_cndmask_b32 v88, v205, v206, s[80:81]
    v_cndmask_b32 v89, v205, v206, s[82:83]
    v_cndmask_b32 v90, v205, v206, s[84:85]
    v_cndmask_b32 v91, v205, v206, s[86:87]
    v_cndmask_b32 v92, v205, v206, s[88:89]
    v_cndmask_b32 v93, v205, v206, s[90:91]
    v_cndmask_b32 v94, v205, v206, s[92:93]
    v_cndmask_b32 v95, v205, v206, s[94:95]
    s_mov_b32 s52, 6
    s_add_u32 s53, s52, s57
    s_cmp_lt_u32 s53, 8
    s_cselect_b32 s54, s50, 0
    v_mov_b32 v96, s54
    v_mov_b32 v97, s54
    v_mov_b32 v98, s54
    v_mov_b32 v99, s54
    v_mov_b32 v100, s54
    v_mov_b32 v101, s54
    v_mov_b32 v102, s54
    v_mov_b32 v103, s54
    v_mov_b32 v104, s54
    v_mov_b32 v105, s54
    v_mov_b32 v106, s54
    v_mov_b32 v107, s54
    v_mov_b32 v108, s54
    v_mov_b32 v109, s54
    v_mov_b32 v110, s54
    v_mov_b32 v111, s54
    s_cmp_gt_u32 s20, 2
    s_cselect_b32 s52, 11, 2
    s_add_u32 s53, s52, s57
    s_cmp_lt_u32 s53, 8
    s_cselect_b32 s54, s50, 0
    s_cmp_eq_u32 s52, s56
    s_cselect_b32 s53, s50, s54
    s_cmp_eq_u32 s52, s20
    s_cselect_b32 s55, s50, s54
    v_mov_b32 v205, s53
    v_mov_b32 v206, s55
    v_cndmask_b32 v112, v205, v206, s[64:65]
    v_cndmask_b32 v113, v205, v206, s[66:67]
    v_cndmask_b32 v114, v205, v206, s[68:69]
    v_cndmask_b32 v115, v205, v206, s[70:71]
    v_cndmask_b32 v116, v205, v206, s[72:73]
    v_cndmask_b32 v117, v205, v206, s[74:75]
    v_cndmask_b32 v118, v205, v206, s[76:77]
    v_cndmask_b32 v119, v205, v206, s[78:79]
    v_cndmask_b32 v120, v205, v206, s[80:81]
    v_cndmask_b32 v121, v205, v206, s[82:83]
    v_cndmask_b32 v122, v205, v206, s[84:85]
    v_cndmask_b32 v123, v205, v206, s[86:87]
    v_cndmask_b32 v124, v205, v206, s[88:89]
    v_cndmask_b32 v125, v205, v206, s[90:91]
    v_cndmask_b32 v126, v205, v206, s[92:93]
    v_cndmask_b32 v127, v205, v206, s[94:95]
    s_mov_b32 s52, 7
    s_add_u32 s53, s52, s57
    s_cmp_lt_u32 s53, 8
    s_cselect_b32 s54, s50, 0
    v_mov_b32 v128, s54
    v_mov_b32 v129, s54
    v_mov_b32 v130, s54
    v_mov_b32 v131, s54
    v_mov_b32 v132, s54
    v_mov_b32 v133, s54
    v_mov_b32 v134, s54
    v_mov_b32 v135, s54
    v_mov_b32 v136, s54
    v_mov_b32 v137, s54
    v_mov_b32 v138, s54
    v_mov_b32 v139, s54
    v_mov_b32 v140, s54
    v_mov_b32 v141, s54
    v_mov_b32 v142, s54
    v_mov_b32 v143, s54
    s_mov_b32 s52, 3
    s_add_u32 s53, s52, s57
    s_cmp_lt_u32 s53, 8
    s_cselect_b32 s54, s50, 0
    s_cmp_eq_u32 s52, s56
    s_cselect_b32 s53, s50, s54
    s_cmp_eq_u32 s52, s20
    s_cselect_b32 s55, s50, s54
    v_mov_b32 v205, s53
    v_mov_b32 v206, s55
    v_cndmask_b32 v144, v205, v206, s[64:65]
    v_cndmask_b32 v145, v205, v206, s[66:67]
    v_cndmask_b32 v146, v205, v206, s[68:69]
    v_cndmask_b32 v147, v205, v206, s[70:71]
    v_cndmask_b32 v148, v205, v206, s[72:73]
    v_cndmask_b32 v149, v205, v206, s[74:75]
    v_cndmask_b32 v150, v205, v206, s[76:77]
    v_cndmask_b32 v151, v205, v206, s[78:79]
    v_cndmask_b32 v152, v205, v206, s[80:81]
    v_cndmask_b32 v153, v205, v206, s[82:83]
    v_cndmask_b32 v154, v205, v206, s[84:85]
    v_cndmask_b32 v155, v205, v206, s[86:87]
    v_cndmask_b32 v156, v205, v206, s[88:89]
    v_cndmask_b32 v157, v205, v206, s[90:91]
    v_cndmask_b32 v158, v205, v206, s[92:93]
    v_cndmask_b32 v159, v205, v206, s[94:95]
    v_mov_b32 v242, 0x7f000000
    s_lshl_b32 s52, s20, 14
    s_add_u32 s52, s52, 0x18000
    v_add_u32 v168, s52, v160
    v_add_u32 v169, s52, v161
    v_add_u32 v170, s52, v162
    v_add_u32 v171, s52, v163
    v_add_u32 v172, s52, v164
    v_add_u32 v173, s52, v165
    v_add_u32 v174, s52, v166
    v_add_u32 v175, s52, v167
    s_waitcnt vmcnt(24)
    ds_read_b128 a[0:3], v168
    ds_read_b128 a[4:7], v169
    ds_read_b128 a[8:11], v170
    ds_read_b128 a[12:15], v171
    ds_read_b128 a[16:19], v172
    ds_read_b128 a[20:23], v173
    ds_read_b128 a[24:27], v174
    ds_read_b128 a[28:31], v175
    ds_read_b128 a[32:35], v168 offset:256
    ds_read_b128 a[36:39], v169 offset:256
    ds_read_b128 a[40:43], v170 offset:256
    ds_read_b128 a[44:47], v171 offset:256
    ds_read_b128 a[48:51], v172 offset:256
    ds_read_b128 a[52:55], v173 offset:256
    ds_read_b128 a[56:59], v174 offset:256
    s_waitcnt lgkmcnt(14)
    ds_read_b128 a[60:63], v175 offset:256
    s_waitcnt lgkmcnt(0)
    s_waitcnt vmcnt(20)
    s_barrier
    s_add_u32 m0, s23, 0x18000
    s_nop 0
    buffer_load_dwordx4 v176, s[8:11], s34 offen nt lds
    buffer_load_dwordx4 v177, s[8:11], s34 offen offset:1024 nt lds
    buffer_load_dwordx4 v178, s[8:11], s34 offen offset:2048 nt lds
    v_add_u32 v168, 0, v160
    ds_read_b128 a[64:67], v168
    buffer_load_dwordx4 v179, s[8:11], s34 offen offset:3072 nt lds
    s_add_u32 m0, s23, 0x1c000
    s_nop 0
    buffer_load_dwordx4 v176, s[8:11], s30 offen nt lds
    buffer_load_dwordx4 v177, s[8:11], s30 offen offset:1024 nt lds
    v_add_u32 v169, 0, v161
    ds_read_b128 a[68:71], v169
    buffer_load_dwordx4 v178, s[8:11], s30 offen offset:2048 nt lds
    buffer_load_dwordx4 v179, s[8:11], s30 offen offset:3072 nt lds
    s_add_u32 m0, s23, 0x20000
    s_nop 0
    buffer_load_dwordx4 v176, s[8:11], s26 offen nt lds
    v_add_u32 v170, 0, v162
    ds_read_b128 a[72:75], v170
    buffer_load_dwordx4 v177, s[8:11], s26 offen offset:1024 nt lds
    buffer_load_dwordx4 v178, s[8:11], s26 offen offset:2048 nt lds
    buffer_load_dwordx4 v179, s[8:11], s26 offen offset:3072 nt lds
    v_add_u32 v171, 0, v163
    ds_read_b128 a[76:79], v171
    s_add_u32 m0, s23, 0x24000
    s_nop 0
    buffer_load_dwordx4 v176, s[8:11], s35 offen nt lds
    buffer_load_dwordx4 v177, s[8:11], s35 offen offset:1024 nt lds
    buffer_load_dwordx4 v178, s[8:11], s35 offen offset:2048 nt lds
    v_add_u32 v172, 0, v164
    ds_read_b128 a[80:83], v172
    buffer_load_dwordx4 v179, s[8:11], s35 offen offset:3072 nt lds
    s_waitcnt lgkmcnt(3)
    v_mfma_f32_32x32x16_bf16 v[16:31], a[64:67], a[0:3], v[16:31]
    v_add_u32 v173, 0, v165
    ds_read_b128 a[84:87], v173
    v_mfma_f32_32x32x16_bf16 v[16:31], a[68:71], a[4:7], v[16:31]
    v_add_u32 v174, 0, v166
    ds_read_b128 a[88:91], v174
    s_waitcnt lgkmcnt(3)
    v_mfma_f32_32x32x16_bf16 v[16:31], a[72:75], a[8:11], v[16:31]
    v_add_u32 v175, 0, v167
    ds_read_b128 a[92:95], v175
    v_mfma_f32_32x32x16_bf16 v[16:31], a[76:79], a[12:15], v[16:31]
    ds_read_b128 a[64:67], v168 offset:256
    s_waitcnt lgkmcnt(3)
    v_mfma_f32_32x32x16_bf16 v[16:31], a[80:83], a[16:19], v[16:31]
    ds_read_b128 a[68:71], v169 offset:256
    v_mfma_f32_32x32x16_bf16 v[16:31], a[84:87], a[20:23], v[16:31]
    ds_read_b128 a[72:75], v170 offset:256
    s_waitcnt lgkmcnt(3)
    v_mfma_f32_32x32x16_bf16 v[16:31], a[88:91], a[24:27], v[16:31]
    ds_read_b128 a[76:79], v171 offset:256
    v_mfma_f32_32x32x16_bf16 v[16:31], a[92:95], a[28:31], v[16:31]
    ds_read_b128 a[80:83], v172 offset:256
    s_waitcnt lgkmcnt(3)
    v_mfma_f32_32x32x16_bf16 v[16:31], a[64:67], a[32:35], v[16:31]
    ds_read_b128 a[84:87], v173 offset:256
    v_mfma_f32_32x32x16_bf16 v[16:31], a[68:71], a[36:39], v[16:31]
    ds_read_b128 a[88:91], v174 offset:256
    s_waitcnt lgkmcnt(3)
    v_mfma_f32_32x32x16_bf16 v[16:31], a[72:75], a[40:43], v[16:31]
    s_waitcnt vmcnt(32)
    s_barrier
    ds_read_b128 a[92:95], v175 offset:256
    v_mfma_f32_32x32x16_bf16 v[16:31], a[76:79], a[44:47], v[16:31]
    ds_read_b128 a[64:67], v168 offset:16384
    s_waitcnt lgkmcnt(3)
    v_mfma_f32_32x32x16_bf16 v[16:31], a[80:83], a[48:51], v[16:31]
    ds_read_b128 a[68:71], v169 offset:16384
    v_mfma_f32_32x32x16_bf16 v[16:31], a[84:87], a[52:55], v[16:31]
    ds_read_b128 a[72:75], v170 offset:16384
    s_waitcnt lgkmcnt(3)
    v_mfma_f32_32x32x16_bf16 v[16:31], a[88:91], a[56:59], v[16:31]
    ds_read_b128 a[76:79], v171 offset:16384
    v_mfma_f32_32x32x16_bf16 v[16:31], a[92:95], a[60:63], v[16:31]
    ds_read_b128 a[80:83], v172 offset:16384
    s_waitcnt lgkmcnt(3)
    v_mfma_f32_32x32x16_bf16 v[32:47], a[64:67], a[0:3], v[32:47]
    ds_read_b128 a[84:87], v173 offset:16384
    v_mfma_f32_32x32x16_bf16 v[32:47], a[68:71], a[4:7], v[32:47]
    ds_read_b128 a[88:91], v174 offset:16384
    s_nop 5
    v_max3_f32 v188, v16, v17, v18
    v_max3_f32 v189, v19, v20, v21
    v_max3_f32 v190, v22, v23, v24
    v_max3_f32 v191, v25, v26, v27
    v_max3_f32 v192, v28, v29, v30
    v_max3_f32 v188, v188, v189, v31
    s_waitcnt lgkmcnt(3)
    v_mfma_f32_32x32x16_bf16 v[32:47], a[72:75], a[8:11], v[32:47]
    ds_read_b128 a[92:95], v175 offset:16384
    v_max3_f32 v190, v190, v191, v192
    v_max3_f32 v188, v188, v190, s51
    v_mul_f32 v224, s49, v188
    v_min_f32 v242, v242, v224
    v_fma_f32 v16, v16, s48, v224
    v_fma_f32 v17, v17, s48, v224
    v_mfma_f32_32x32x16_bf16 v[32:47], a[76:79], a[12:15], v[32:47]
    ds_read_b128 a[64:67], v168 offset:16640
    v_exp_f32 v16, v16
    v_fma_f32 v18, v18, s48, v224
    v_exp_f32 v17, v17
    v_fma_f32 v19, v19, s48, v224
    s_waitcnt lgkmcnt(3)
    v_mfma_f32_32x32x16_bf16 v[32:47], a[80:83], a[16:19], v[32:47]
    ds_read_b128 a[68:71], v169 offset:16640
    v_exp_f32 v18, v18
    v_fma_f32 v20, v20, s48, v224
    v_exp_f32 v19, v19
    v_add_f32 v233, v16, v17
    v_mfma_f32_32x32x16_bf16 v[32:47], a[84:87], a[20:23], v[32:47]
    ds_read_b128 a[72:75], v170 offset:16640
    v_fma_f32 v21, v21, s48, v224
    v_exp_f32 v20, v20
    v_add_f32 v233, v233, v18
    v_fma_f32 v22, v22, s48, v224
    v_exp_f32 v21, v21
    s_waitcnt lgkmcnt(3)
    v_mfma_f32_32x32x16_bf16 v[32:47], a[88:91], a[24:27], v[32:47]
    ds_read_b128 a[76:79], v171 offset:16640
    v_add_f32 v233, v233, v19
    v_fma_f32 v23, v23, s48, v224
    v_exp_f32 v22, v22
    v_add_f32 v233, v233, v20
    v_fma_f32 v24, v24, s48, v224
    v_mfma_f32_32x32x16_bf16 v[32:47], a[92:95], a[28:31], v[32:47]
    ds_read_b128 a[80:83], v172 offset:16640
    v_exp_f32 v23, v23
    v_add_f32 v233, v233, v21
    v_fma_f32 v25, v25, s48, v224
    v_exp_f32 v24, v24
    s_waitcnt lgkmcnt(3)
    v_mfma_f32_32x32x16_bf16 v[32:47], a[64:67], a[32:35], v[32:47]
    ds_read_b128 a[84:87], v173 offset:16640
    v_add_f32 v233, v233, v22
    v_fma_f32 v26, v26, s48, v224
    v_exp_f32 v25, v25
    v_add_f32 v233, v233, v23
    v_fma_f32 v27, v27, s48, v224
    v_mfma_f32_32x32x16_bf16 v[32:47], a[68:71], a[36:39], v[32:47]
    ds_read_b128 a[88:91], v174 offset:16640
    v_exp_f32 v26, v26
    v_add_f32 v233, v233, v24
    v_fma_f32 v28, v28, s48, v224
    v_exp_f32 v27, v27
    s_waitcnt lgkmcnt(3)
    v_mfma_f32_32x32x16_bf16 v[32:47], a[72:75], a[40:43], v[32:47]
    s_waitcnt vmcnt(24)
    s_barrier
    ds_read_b128 a[92:95], v175 offset:16640
    s_add_u32 m0, s23, 0
    s_nop 0
    buffer_load_dwordx4 v176, s[8:11], s31 offen nt lds
    v_add_f32 v233, v233, v25
    v_mfma_f32_32x32x16_bf16 v[32:47], a[76:79], a[44:47], v[32:47]
    s_and_b32 s53, s44, 0x4000
    s_add_u32 s53, s53, 0x8000
    v_add_u32 v168, s53, v160
    ds_read_b128 a[64:67], v168
    buffer_load_dwordx4 v177, s[8:11], s31 offen offset:1024 nt lds
    v_fma_f32 v29, v29, s48, v224
    s_waitcnt lgkmcnt(3)
    v_mfma_f32_32x32x16_bf16 v[32:47], a[80:83], a[48:51], v[32:47]
    v_add_u32 v169, s53, v161
    ds_read_b128 a[68:71], v169
    buffer_load_dwordx4 v178, s[8:11], s31 offen offset:2048 nt lds
    v_exp_f32 v28, v28
    v_add_f32 v233, v233, v26
    v_mfma_f32_32x32x16_bf16 v[32:47], a[84:87], a[52:55], v[32:47]
    v_add_u32 v170, s53, v162
    ds_read_b128 a[72:75], v170
    buffer_load_dwordx4 v179, s[8:11], s31 offen offset:3072 nt lds
    v_fma_f32 v30, v30, s48, v224
    v_exp_f32 v29, v29
    s_waitcnt lgkmcnt(3)
    v_mfma_f32_32x32x16_bf16 v[32:47], a[88:91], a[56:59], v[32:47]
    v_add_u32 v171, s53, v163
    ds_read_b128 a[76:79], v171
    v_add_f32 v233, v233, v27
    v_fma_f32 v31, v31, s48, v224
    v_exp_f32 v30, v30
    v_add_f32 v233, v233, v28
    v_mfma_f32_32x32x16_bf16 v[32:47], a[92:95], a[60:63], v[32:47]
    v_add_u32 v172, s53, v164
    ds_read_b128 a[80:83], v172
    v_exp_f32 v31, v31
    v_add_f32 v233, v233, v29
    v_add_f32 v233, v233, v30
    v_add_f32 v233, v233, v31
    s_waitcnt lgkmcnt(3)
    v_mfma_f32_32x32x16_bf16 v[48:63], a[64:67], a[0:3], v[48:63]
    v_add_u32 v173, s53, v165
    ds_read_b128 a[84:87], v173
    v_mfma_f32_32x32x16_bf16 v[48:63], a[68:71], a[4:7], v[48:63]
    v_add_u32 v174, s53, v166
    ds_read_b128 a[88:91], v174
    v_max3_f32 v188, v32, v33, v34
    v_max3_f32 v189, v35, v36, v37
    v_max3_f32 v190, v38, v39, v40
    v_max3_f32 v191, v41, v42, v43
    v_max3_f32 v192, v44, v45, v46
    s_waitcnt lgkmcnt(3)
    v_mfma_f32_32x32x16_bf16 v[48:63], a[72:75], a[8:11], v[48:63]
    v_add_u32 v175, s53, v167
    ds_read_b128 a[92:95], v175
    v_max3_f32 v188, v188, v189, v47
    v_max3_f32 v190, v190, v191, v192
    v_max3_f32 v188, v188, v190, s51
    v_mul_f32 v225, s49, v188
    v_min_f32 v242, v242, v225
    v_mfma_f32_32x32x16_bf16 v[48:63], a[76:79], a[12:15], v[48:63]
    ds_read_b128 a[64:67], v168 offset:256
    v_fma_f32 v32, v32, s48, v225
    v_fma_f32 v33, v33, s48, v225
    v_exp_f32 v32, v32
    v_fma_f32 v34, v34, s48, v225
    v_exp_f32 v33, v33
    s_waitcnt lgkmcnt(3)
    v_mfma_f32_32x32x16_bf16 v[48:63], a[80:83], a[16:19], v[48:63]
    ds_read_b128 a[68:71], v169 offset:256
    v_fma_f32 v35, v35, s48, v225
    v_exp_f32 v34, v34
    v_fma_f32 v36, v36, s48, v225
    v_exp_f32 v35, v35
    v_mfma_f32_32x32x16_bf16 v[48:63], a[84:87], a[20:23], v[48:63]
    ds_read_b128 a[72:75], v170 offset:256
    v_add_f32 v234, v32, v33
    v_fma_f32 v37, v37, s48, v225
    v_exp_f32 v36, v36
    v_add_f32 v234, v234, v34
    v_fma_f32 v38, v38, s48, v225
    s_waitcnt lgkmcnt(3)
    v_mfma_f32_32x32x16_bf16 v[48:63], a[88:91], a[24:27], v[48:63]
    ds_read_b128 a[76:79], v171 offset:256
    v_exp_f32 v37, v37
    v_add_f32 v234, v234, v35
    v_fma_f32 v39, v39, s48, v225
    v_exp_f32 v38, v38
    v_mfma_f32_32x32x16_bf16 v[48:63], a[92:95], a[28:31], v[48:63]
    ds_read_b128 a[80:83], v172 offset:256
    v_add_f32 v234, v234, v36
    v_fma_f32 v40, v40, s48, v225
    v_exp_f32 v39, v39
    v_add_f32 v234, v234, v37
    v_fma_f32 v41, v41, s48, v225
    s_waitcnt lgkmcnt(3)
    v_mfma_f32_32x32x16_bf16 v[48:63], a[64:67], a[32:35], v[48:63]
    ds_read_b128 a[84:87], v173 offset:256
    v_exp_f32 v40, v40
    v_add_f32 v234, v234, v38
    v_fma_f32 v42, v42, s48, v225
    v_exp_f32 v41, v41
    v_mfma_f32_32x32x16_bf16 v[48:63], a[68:71], a[36:39], v[48:63]
    ds_read_b128 a[88:91], v174 offset:256
    v_add_f32 v234, v234, v39
    v_fma_f32 v43, v43, s48, v225
    v_exp_f32 v42, v42
    v_add_f32 v234, v234, v40
    v_fma_f32 v44, v44, s48, v225
    s_waitcnt lgkmcnt(3)
    v_mfma_f32_32x32x16_bf16 v[48:63], a[72:75], a[40:43], v[48:63]
    s_waitcnt vmcnt(24)
    s_barrier
    ds_read_b128 a[92:95], v175 offset:256
    s_add_u32 m0, s23, 0x4000
    s_nop 0
    buffer_load_dwordx4 v176, s[8:11], s27 offen nt lds
    v_exp_f32 v43, v43
    v_mfma_f32_32x32x16_bf16 v[48:63], a[76:79], a[44:47], v[48:63]
    v_add_u32 v168, 0x10000, v160
    ds_read_b128 a[64:67], v168
    buffer_load_dwordx4 v177, s[8:11], s27 offen offset:1024 nt lds
    v_add_f32 v234, v234, v41
    v_fma_f32 v45, v45, s48, v225
    v_exp_f32 v44, v44
    s_waitcnt lgkmcnt(3)
    v_mfma_f32_32x32x16_bf16 v[48:63], a[80:83], a[48:51], v[48:63]
    v_add_u32 v169, 0x10000, v161
    ds_read_b128 a[68:71], v169
    buffer_load_dwordx4 v178, s[8:11], s27 offen offset:2048 nt lds
    v_add_f32 v234, v234, v42
    v_fma_f32 v46, v46, s48, v225
    v_exp_f32 v45, v45
    v_mfma_f32_32x32x16_bf16 v[48:63], a[84:87], a[52:55], v[48:63]
    v_add_u32 v170, 0x10000, v162
    ds_read_b128 a[72:75], v170
    buffer_load_dwordx4 v179, s[8:11], s27 offen offset:3072 nt lds
    v_add_f32 v234, v234, v43
    v_fma_f32 v47, v47, s48, v225
    v_exp_f32 v46, v46
    s_waitcnt lgkmcnt(3)
    v_mfma_f32_32x32x16_bf16 v[48:63], a[88:91], a[56:59], v[48:63]
    v_add_u32 v171, 0x10000, v163
    ds_read_b128 a[76:79], v171
    v_add_f32 v234, v234, v44
    v_exp_f32 v47, v47
    v_add_f32 v234, v234, v45
    v_add_f32 v234, v234, v46
    v_mfma_f32_32x32x16_bf16 v[48:63], a[92:95], a[60:63], v[48:63]
    v_add_u32 v172, 0x10000, v164
    ds_read_b128 a[80:83], v172
    v_add_f32 v234, v234, v47
    s_waitcnt lgkmcnt(3)
    v_mfma_f32_32x32x16_bf16 v[64:79], a[64:67], a[0:3], v[64:79]
    v_add_u32 v173, 0x10000, v165
    ds_read_b128 a[84:87], v173
    v_mfma_f32_32x32x16_bf16 v[64:79], a[68:71], a[4:7], v[64:79]
    v_add_u32 v174, 0x10000, v166
    ds_read_b128 a[88:91], v174
    s_nop 1
    v_max3_f32 v188, v48, v49, v50
    v_max3_f32 v189, v51, v52, v53
    v_max3_f32 v190, v54, v55, v56
    v_max3_f32 v191, v57, v58, v59
    v_max3_f32 v192, v60, v61, v62
    s_waitcnt lgkmcnt(3)
    v_mfma_f32_32x32x16_bf16 v[64:79], a[72:75], a[8:11], v[64:79]
    v_add_u32 v175, 0x10000, v167
    ds_read_b128 a[92:95], v175
    v_max3_f32 v188, v188, v189, v63
    v_max3_f32 v190, v190, v191, v192
    v_max3_f32 v188, v188, v190, s51
    v_mul_f32 v226, s49, v188
    v_min_f32 v242, v242, v226
    v_mfma_f32_32x32x16_bf16 v[64:79], a[76:79], a[12:15], v[64:79]
    ds_read_b128 a[64:67], v168 offset:256
    v_fma_f32 v48, v48, s48, v226
    v_fma_f32 v49, v49, s48, v226
    v_exp_f32 v48, v48
    v_fma_f32 v50, v50, s48, v226
    v_exp_f32 v49, v49
    s_waitcnt lgkmcnt(3)
    v_mfma_f32_32x32x16_bf16 v[64:79], a[80:83], a[16:19], v[64:79]
    ds_read_b128 a[68:71], v169 offset:256
    v_fma_f32 v51, v51, s48, v226
    v_exp_f32 v50, v50
    v_fma_f32 v52, v52, s48, v226
    v_exp_f32 v51, v51
    v_mfma_f32_32x32x16_bf16 v[64:79], a[84:87], a[20:23], v[64:79]
    ds_read_b128 a[72:75], v170 offset:256
    v_add_f32 v235, v48, v49
    v_fma_f32 v53, v53, s48, v226
    v_exp_f32 v52, v52
    v_add_f32 v235, v235, v50
    v_fma_f32 v54, v54, s48, v226
    s_waitcnt lgkmcnt(3)
    v_mfma_f32_32x32x16_bf16 v[64:79], a[88:91], a[24:27], v[64:79]
    ds_read_b128 a[76:79], v171 offset:256
    v_exp_f32 v53, v53
    v_add_f32 v235, v235, v51
    v_fma_f32 v55, v55, s48, v226
    v_exp_f32 v54, v54
    v_mfma_f32_32x32x16_bf16 v[64:79], a[92:95], a[28:31], v[64:79]
    ds_read_b128 a[80:83], v172 offset:256
    v_add_f32 v235, v235, v52
    v_fma_f32 v56, v56, s48, v226
    v_exp_f32 v55, v55
    v_add_f32 v235, v235, v53
    v_fma_f32 v57, v57, s48, v226
    s_waitcnt lgkmcnt(3)
    v_mfma_f32_32x32x16_bf16 v[64:79], a[64:67], a[32:35], v[64:79]
    ds_read_b128 a[84:87], v173 offset:256
    v_exp_f32 v56, v56
    v_add_f32 v235, v235, v54
    v_fma_f32 v58, v58, s48, v226
    v_exp_f32 v57, v57
    v_mfma_f32_32x32x16_bf16 v[64:79], a[68:71], a[36:39], v[64:79]
    ds_read_b128 a[88:91], v174 offset:256
    v_add_f32 v235, v235, v55
    v_fma_f32 v59, v59, s48, v226
    v_exp_f32 v58, v58
    v_add_f32 v235, v235, v56
    v_fma_f32 v60, v60, s48, v226
    s_waitcnt lgkmcnt(3)
    v_mfma_f32_32x32x16_bf16 v[64:79], a[72:75], a[40:43], v[64:79]
    s_waitcnt vmcnt(20)
    s_barrier
    ds_read_b128 a[92:95], v175 offset:256
    s_add_u32 m0, s36, 0x8000
    s_nop 0
    buffer_load_dwordx4 v1, s[12:15], s28 offen nt lds
    v_exp_f32 v59, v59
    v_mfma_f32_32x32x16_bf16 v[64:79], a[76:79], a[44:47], v[64:79]
    s_and_b32 s53, s45, 0x4000
    s_add_u32 s53, s53, 0x14000
    v_add_u32 v168, s53, v160
    ds_read_b128 a[64:67], v168
    buffer_load_dwordx4 v2, s[12:15], s28 offen offset:1024 nt lds
    v_add_f32 v235, v235, v57
    s_waitcnt lgkmcnt(3)
    v_mfma_f32_32x32x16_bf16 v[64:79], a[80:83], a[48:51], v[64:79]
    v_add_u32 v169, s53, v161
    ds_read_b128 a[68:71], v169
    s_add_u32 m0, s36, 0xa000
    s_nop 0
    buffer_load_dwordx4 v1, s[12:15], s32 offen nt lds
    v_fma_f32 v61, v61, s48, v226
    v_exp_f32 v60, v60
    v_mfma_f32_32x32x16_bf16 v[64:79], a[84:87], a[52:55], v[64:79]
    v_add_u32 v170, s53, v162
    ds_read_b128 a[72:75], v170
    buffer_load_dwordx4 v2, s[12:15], s32 offen offset:1024 nt lds
    v_add_f32 v235, v235, v58
    v_fma_f32 v62, v62, s48, v226
    v_exp_f32 v61, v61
    s_waitcnt lgkmcnt(3)
    v_mfma_f32_32x32x16_bf16 v[64:79], a[88:91], a[56:59], v[64:79]
    v_add_u32 v171, s53, v163
    ds_read_b128 a[76:79], v171
    s_add_u32 m0, s36, 0xc000
    s_nop 0
    buffer_load_dwordx4 v1, s[12:15], s24 offen nt lds
    v_add_f32 v235, v235, v59
    v_fma_f32 v63, v63, s48, v226
    v_mfma_f32_32x32x16_bf16 v[64:79], a[92:95], a[60:63], v[64:79]
    v_add_u32 v172, s53, v164
    ds_read_b128 a[80:83], v172
    buffer_load_dwordx4 v2, s[12:15], s24 offen offset:1024 nt lds
    v_exp_f32 v62, v62
    v_add_f32 v235, v235, v60
    s_waitcnt lgkmcnt(3)
    v_mfma_f32_32x32x16_bf16 v[80:95], a[64:67], a[0:3], v[80:95]
    v_add_u32 v173, s53, v165
    ds_read_b128 a[84:87], v173
    s_add_u32 m0, s36, 0xe000
    s_nop 0
    buffer_load_dwordx4 v1, s[12:15], s33 offen nt lds
    v_exp_f32 v63, v63
    v_mfma_f32_32x32x16_bf16 v[80:95], a[68:71], a[4:7], v[80:95]
    v_add_u32 v174, s53, v166
    ds_read_b128 a[88:91], v174
    buffer_load_dwordx4 v2, s[12:15], s33 offen offset:1024 nt lds
    v_add_f32 v235, v235, v61
    v_add_f32 v235, v235, v62
    v_add_f32 v235, v235, v63
    s_waitcnt lgkmcnt(3)
    v_mfma_f32_32x32x16_bf16 v[80:95], a[72:75], a[8:11], v[80:95]
    v_add_u32 v175, s53, v167
    ds_read_b128 a[92:95], v175
    v_max3_f32 v188, v64, v65, v66
    v_max3_f32 v189, v67, v68, v69
    v_max3_f32 v190, v70, v71, v72
    v_max3_f32 v191, v73, v74, v75
    v_max3_f32 v192, v76, v77, v78
    v_mfma_f32_32x32x16_bf16 v[80:95], a[76:79], a[12:15], v[80:95]
    ds_read_b128 a[64:67], v168 offset:256
    v_max3_f32 v188, v188, v189, v79
    v_max3_f32 v190, v190, v191, v192
    v_max3_f32 v188, v188, v190, s51
    v_mul_f32 v227, s49, v188
    v_min_f32 v242, v242, v227
    v_fma_f32 v64, v64, s48, v227
    s_waitcnt lgkmcnt(3)
    v_mfma_f32_32x32x16_bf16 v[80:95], a[80:83], a[16:19], v[80:95]
    ds_read_b128 a[68:71], v169 offset:256
    v_fma_f32 v65, v65, s48, v227
    v_exp_f32 v64, v64
    v_fma_f32 v66, v66, s48, v227
    v_exp_f32 v65, v65
    v_mfma_f32_32x32x16_bf16 v[80:95], a[84:87], a[20:23], v[80:95]
    ds_read_b128 a[72:75], v170 offset:256
    v_fma_f32 v67, v67, s48, v227
    v_exp_f32 v66, v66
    v_fma_f32 v68, v68, s48, v227
    v_exp_f32 v67, v67
    s_waitcnt lgkmcnt(3)
    v_mfma_f32_32x32x16_bf16 v[80:95], a[88:91], a[24:27], v[80:95]
    ds_read_b128 a[76:79], v171 offset:256
    v_add_f32 v236, v64, v65
    v_fma_f32 v69, v69, s48, v227
    v_exp_f32 v68, v68
    v_add_f32 v236, v236, v66
    v_fma_f32 v70, v70, s48, v227
    v_mfma_f32_32x32x16_bf16 v[80:95], a[92:95], a[28:31], v[80:95]
    ds_read_b128 a[80:83], v172 offset:256
    v_exp_f32 v69, v69
    v_add_f32 v236, v236, v67
    v_fma_f32 v71, v71, s48, v227
    v_exp_f32 v70, v70
    s_waitcnt lgkmcnt(3)
    v_mfma_f32_32x32x16_bf16 v[80:95], a[64:67], a[32:35], v[80:95]
    ds_read_b128 a[84:87], v173 offset:256
    v_add_f32 v236, v236, v68
    v_fma_f32 v72, v72, s48, v227
    v_exp_f32 v71, v71
    v_add_f32 v236, v236, v69
    v_fma_f32 v73, v73, s48, v227
    v_mfma_f32_32x32x16_bf16 v[80:95], a[68:71], a[36:39], v[80:95]
    ds_read_b128 a[88:91], v174 offset:256
    v_exp_f32 v72, v72
    v_add_f32 v236, v236, v70
    v_fma_f32 v74, v74, s48, v227
    v_exp_f32 v73, v73
    s_waitcnt lgkmcnt(3)
    v_mfma_f32_32x32x16_bf16 v[80:95], a[72:75], a[40:43], v[80:95]
    s_waitcnt vmcnt(24)
    s_barrier
    ds_read_b128 a[92:95], v175 offset:256
    s_add_u32 m0, s36, 0x10000
    s_nop 0
    buffer_load_dwordx4 v1, s[12:15], s29 offen nt lds
    v_add_f32 v236, v236, v71
    v_mfma_f32_32x32x16_bf16 v[80:95], a[76:79], a[44:47], v[80:95]
    v_add_u32 v168, 0x1c000, v160
    ds_read_b128 a[64:67], v168
    buffer_load_dwordx4 v2, s[12:15], s29 offen offset:1024 nt lds
    v_fma_f32 v75, v75, s48, v227
    v_exp_f32 v74, v74
    s_waitcnt lgkmcnt(3)
    v_mfma_f32_32x32x16_bf16 v[80:95], a[80:83], a[48:51], v[80:95]
    v_add_u32 v169, 0x1c000, v161
    ds_read_b128 a[68:71], v169
    s_add_u32 m0, s36, 0x12000
    s_nop 0
    buffer_load_dwordx4 v1, s[12:15], s25 offen nt lds
    v_add_f32 v236, v236, v72
    v_fma_f32 v76, v76, s48, v227
    v_mfma_f32_32x32x16_bf16 v[80:95], a[84:87], a[52:55], v[80:95]
    v_add_u32 v170, 0x1c000, v162
    ds_read_b128 a[72:75], v170
    buffer_load_dwordx4 v2, s[12:15], s25 offen offset:1024 nt lds
    v_exp_f32 v75, v75
    v_add_f32 v236, v236, v73
    s_waitcnt lgkmcnt(3)
    v_mfma_f32_32x32x16_bf16 v[80:95], a[88:91], a[56:59], v[80:95]
    v_add_u32 v171, 0x1c000, v163
    ds_read_b128 a[76:79], v171
    v_fma_f32 v77, v77, s48, v227
    v_exp_f32 v76, v76
    v_add_f32 v236, v236, v74
    v_fma_f32 v78, v78, s48, v227
    v_mfma_f32_32x32x16_bf16 v[80:95], a[92:95], a[60:63], v[80:95]
    v_add_u32 v172, 0x1c000, v164
    ds_read_b128 a[80:83], v172
    v_exp_f32 v77, v77
    v_add_f32 v236, v236, v75
    v_fma_f32 v79, v79, s48, v227
    v_exp_f32 v78, v78
    s_waitcnt lgkmcnt(3)
    v_mfma_f32_32x32x16_bf16 v[96:111], a[64:67], a[0:3], v[96:111]
    v_add_u32 v173, 0x1c000, v165
    ds_read_b128 a[84:87], v173
    v_add_f32 v236, v236, v76
    v_exp_f32 v79, v79
    v_add_f32 v236, v236, v77
    v_add_f32 v236, v236, v78
    v_mfma_f32_32x32x16_bf16 v[96:111], a[68:71], a[4:7], v[96:111]
    v_add_u32 v174, 0x1c000, v166
    ds_read_b128 a[88:91], v174
    v_add_f32 v236, v236, v79
    v_max3_f32 v188, v80, v81, v82
    v_max3_f32 v189, v83, v84, v85
    v_max3_f32 v190, v86, v87, v88
    v_max3_f32 v191, v89, v90, v91
    s_waitcnt lgkmcnt(3)
    v_mfma_f32_32x32x16_bf16 v[96:111], a[72:75], a[8:11], v[96:111]
    v_add_u32 v175, 0x1c000, v167
    ds_read_b128 a[92:95], v175
    v_max3_f32 v192, v92, v93, v94
    v_max3_f32 v188, v188, v189, v95
    v_max3_f32 v190, v190, v191, v192
    v_max3_f32 v188, v188, v190, s51
    v_mul_f32 v228, s49, v188
    v_mfma_f32_32x32x16_bf16 v[96:111], a[76:79], a[12:15], v[96:111]
    ds_read_b128 a[64:67], v168 offset:256
    v_min_f32 v242, v242, v228
    v_fma_f32 v80, v80, s48, v228
    v_fma_f32 v81, v81, s48, v228
    v_exp_f32 v80, v80
    v_fma_f32 v82, v82, s48, v228
    s_waitcnt lgkmcnt(3)
    v_mfma_f32_32x32x16_bf16 v[96:111], a[80:83], a[16:19], v[96:111]
    ds_read_b128 a[68:71], v169 offset:256
    v_exp_f32 v81, v81
    v_fma_f32 v83, v83, s48, v228
    v_exp_f32 v82, v82
    v_fma_f32 v84, v84, s48, v228
    v_mfma_f32_32x32x16_bf16 v[96:111], a[84:87], a[20:23], v[96:111]
    ds_read_b128 a[72:75], v170 offset:256
    v_exp_f32 v83, v83
    v_add_f32 v237, v80, v81
    v_fma_f32 v85, v85, s48, v228
    v_exp_f32 v84, v84
    s_waitcnt lgkmcnt(3)
    v_mfma_f32_32x32x16_bf16 v[96:111], a[88:91], a[24:27], v[96:111]
    ds_read_b128 a[76:79], v171 offset:256
    v_add_f32 v237, v237, v82
    v_fma_f32 v86, v86, s48, v228
    v_exp_f32 v85, v85
    v_add_f32 v237, v237, v83
    v_fma_f32 v87, v87, s48, v228
    v_mfma_f32_32x32x16_bf16 v[96:111], a[92:95], a[28:31], v[96:111]
    ds_read_b128 a[80:83], v172 offset:256
    v_exp_f32 v86, v86
    v_add_f32 v237, v237, v84
    v_fma_f32 v88, v88, s48, v228
    v_exp_f32 v87, v87
    s_waitcnt lgkmcnt(3)
    v_mfma_f32_32x32x16_bf16 v[96:111], a[64:67], a[32:35], v[96:111]
    ds_read_b128 a[84:87], v173 offset:256
    v_add_f32 v237, v237, v85
    v_fma_f32 v89, v89, s48, v228
    v_exp_f32 v88, v88
    v_add_f32 v237, v237, v86
    v_fma_f32 v90, v90, s48, v228
    v_mfma_f32_32x32x16_bf16 v[96:111], a[68:71], a[36:39], v[96:111]
    ds_read_b128 a[88:91], v174 offset:256
    v_exp_f32 v89, v89
    v_add_f32 v237, v237, v87
    v_fma_f32 v91, v91, s48, v228
    v_exp_f32 v90, v90
    s_waitcnt lgkmcnt(3)
    v_mfma_f32_32x32x16_bf16 v[96:111], a[72:75], a[40:43], v[96:111]
    s_waitcnt vmcnt(20)
    s_barrier
    ds_read_b128 a[92:95], v175 offset:256
    s_add_u32 m0, s36, 0x14000
    s_nop 0
    buffer_load_dwordx4 v1, s[12:15], s34 offen nt lds
    v_add_f32 v237, v237, v88
    v_mfma_f32_32x32x16_bf16 v[96:111], a[76:79], a[44:47], v[96:111]
    s_and_b32 s53, s46, 0x4000
    s_add_u32 s53, s53, 0x20000
    v_add_u32 v168, s53, v160
    ds_read_b128 a[64:67], v168
    buffer_load_dwordx4 v2, s[12:15], s34 offen offset:1024 nt lds
    v_fma_f32 v92, v92, s48, v228
    s_waitcnt lgkmcnt(3)
    v_mfma_f32_32x32x16_bf16 v[96:111], a[80:83], a[48:51], v[96:111]
    v_add_u32 v169, s53, v161
    ds_read_b128 a[68:71], v169
    s_add_u32 m0, s36, 0x16000
    s_nop 0
    buffer_load_dwordx4 v1, s[12:15], s30 offen nt lds
    v_exp_f32 v91, v91
    v_mfma_f32_32x32x16_bf16 v[96:111], a[84:87], a[52:55], v[96:111]
    v_add_u32 v170, s53, v162
    ds_read_b128 a[72:75], v170
    buffer_load_dwordx4 v2, s[12:15], s30 offen offset:1024 nt lds
    v_add_f32 v237, v237, v89
    v_fma_f32 v93, v93, s48, v228
    v_exp_f32 v92, v92
    s_waitcnt lgkmcnt(3)
    v_mfma_f32_32x32x16_bf16 v[96:111], a[88:91], a[56:59], v[96:111]
    v_add_u32 v171, s53, v163
    ds_read_b128 a[76:79], v171
    s_add_u32 m0, s36, 0x18000
    s_nop 0
    buffer_load_dwordx4 v1, s[12:15], s26 offen nt lds
    v_add_f32 v237, v237, v90
    v_fma_f32 v94, v94, s48, v228
    v_mfma_f32_32x32x16_bf16 v[96:111], a[92:95], a[60:63], v[96:111]
    v_add_u32 v172, s53, v164
    ds_read_b128 a[80:83], v172
    buffer_load_dwordx4 v2, s[12:15], s26 offen offset:1024 nt lds
    v_exp_f32 v93, v93
    v_add_f32 v237, v237, v91
    s_waitcnt lgkmcnt(3)
    v_mfma_f32_32x32x16_bf16 v[112:127], a[64:67], a[0:3], v[112:127]
    v_add_u32 v173, s53, v165
    ds_read_b128 a[84:87], v173
    s_add_u32 m0, s36, 0x1a000
    s_nop 0
    buffer_load_dwordx4 v1, s[12:15], s35 offen nt lds
    v_fma_f32 v95, v95, s48, v228
    v_exp_f32 v94, v94
    v_mfma_f32_32x32x16_bf16 v[112:127], a[68:71], a[4:7], v[112:127]
    v_add_u32 v174, s53, v166
    ds_read_b128 a[88:91], v174
    buffer_load_dwordx4 v2, s[12:15], s35 offen offset:1024 nt lds
    v_add_f32 v237, v237, v92
    v_exp_f32 v95, v95
    v_add_f32 v237, v237, v93
    v_add_f32 v237, v237, v94
    v_add_f32 v237, v237, v95
    s_waitcnt lgkmcnt(3)
    v_mfma_f32_32x32x16_bf16 v[112:127], a[72:75], a[8:11], v[112:127]
    v_add_u32 v175, s53, v167
    ds_read_b128 a[92:95], v175
    v_max3_f32 v188, v96, v97, v98
    v_max3_f32 v189, v99, v100, v101
    v_max3_f32 v190, v102, v103, v104
    v_max3_f32 v191, v105, v106, v107
    v_max3_f32 v192, v108, v109, v110
    v_mfma_f32_32x32x16_bf16 v[112:127], a[76:79], a[12:15], v[112:127]
    ds_read_b128 a[64:67], v168 offset:256
    v_max3_f32 v188, v188, v189, v111
    v_max3_f32 v190, v190, v191, v192
    v_max3_f32 v188, v188, v190, s51
    v_mul_f32 v229, s49, v188
    v_min_f32 v242, v242, v229
    v_fma_f32 v96, v96, s48, v229
    s_waitcnt lgkmcnt(3)
    v_mfma_f32_32x32x16_bf16 v[112:127], a[80:83], a[16:19], v[112:127]
    ds_read_b128 a[68:71], v169 offset:256
    v_fma_f32 v97, v97, s48, v229
    v_exp_f32 v96, v96
    v_fma_f32 v98, v98, s48, v229
    v_exp_f32 v97, v97
    v_mfma_f32_32x32x16_bf16 v[112:127], a[84:87], a[20:23], v[112:127]
    ds_read_b128 a[72:75], v170 offset:256
    v_fma_f32 v99, v99, s48, v229
    v_exp_f32 v98, v98
    v_fma_f32 v100, v100, s48, v229
    v_exp_f32 v99, v99
    s_waitcnt lgkmcnt(3)
    v_mfma_f32_32x32x16_bf16 v[112:127], a[88:91], a[24:27], v[112:127]
    ds_read_b128 a[76:79], v171 offset:256
    v_add_f32 v238, v96, v97
    v_fma_f32 v101, v101, s48, v229
    v_exp_f32 v100, v100
    v_add_f32 v238, v238, v98
    v_fma_f32 v102, v102, s48, v229
    v_mfma_f32_32x32x16_bf16 v[112:127], a[92:95], a[28:31], v[112:127]
    ds_read_b128 a[80:83], v172 offset:256
    v_exp_f32 v101, v101
    v_add_f32 v238, v238, v99
    v_fma_f32 v103, v103, s48, v229
    v_exp_f32 v102, v102
    s_waitcnt lgkmcnt(3)
    v_mfma_f32_32x32x16_bf16 v[112:127], a[64:67], a[32:35], v[112:127]
    ds_read_b128 a[84:87], v173 offset:256
    v_add_f32 v238, v238, v100
    v_fma_f32 v104, v104, s48, v229
    v_exp_f32 v103, v103
    v_add_f32 v238, v238, v101
    v_fma_f32 v105, v105, s48, v229
    v_mfma_f32_32x32x16_bf16 v[112:127], a[68:71], a[36:39], v[112:127]
    ds_read_b128 a[88:91], v174 offset:256
    v_exp_f32 v104, v104
    v_add_f32 v238, v238, v102
    v_fma_f32 v106, v106, s48, v229
    v_exp_f32 v105, v105
    s_waitcnt lgkmcnt(3)
    v_mfma_f32_32x32x16_bf16 v[112:127], a[72:75], a[40:43], v[112:127]
    s_waitcnt vmcnt(24)
    s_barrier
    ds_read_b128 a[92:95], v175 offset:256
    s_add_u32 m0, s36, 0x1c000
    s_nop 0
    buffer_load_dwordx4 v1, s[12:15], s31 offen nt lds
    v_add_f32 v238, v238, v103
    v_mfma_f32_32x32x16_bf16 v[112:127], a[76:79], a[44:47], v[112:127]
    v_add_u32 v168, 0, v160
    ds_read_b128 a[64:67], v168
    buffer_load_dwordx4 v2, s[12:15], s31 offen offset:1024 nt lds
    v_fma_f32 v107, v107, s48, v229
    v_exp_f32 v106, v106
    s_waitcnt lgkmcnt(3)
    v_mfma_f32_32x32x16_bf16 v[112:127], a[80:83], a[48:51], v[112:127]
    v_add_u32 v169, 0, v161
    ds_read_b128 a[68:71], v169
    s_add_u32 m0, s36, 0x1e000
    s_nop 0
    buffer_load_dwordx4 v1, s[12:15], s27 offen nt lds
    v_add_f32 v238, v238, v104
    v_fma_f32 v108, v108, s48, v229
    v_mfma_f32_32x32x16_bf16 v[112:127], a[84:87], a[52:55], v[112:127]
    v_add_u32 v170, 0, v162
    ds_read_b128 a[72:75], v170
    buffer_load_dwordx4 v2, s[12:15], s27 offen offset:1024 nt lds
    v_exp_f32 v107, v107
    v_add_f32 v238, v238, v105
    s_waitcnt lgkmcnt(3)
    v_mfma_f32_32x32x16_bf16 v[112:127], a[88:91], a[56:59], v[112:127]
    v_add_u32 v171, 0, v163
    ds_read_b128 a[76:79], v171
    v_fma_f32 v109, v109, s48, v229
    v_exp_f32 v108, v108
    v_add_f32 v238, v238, v106
    v_fma_f32 v110, v110, s48, v229
    v_mfma_f32_32x32x16_bf16 v[112:127], a[92:95], a[60:63], v[112:127]
    v_add_u32 v172, 0, v164
    ds_read_b128 a[80:83], v172
    v_exp_f32 v109, v109
    v_add_f32 v238, v238, v107
    v_fma_f32 v111, v111, s48, v229
    v_exp_f32 v110, v110
    s_waitcnt lgkmcnt(3)
    v_mfma_f32_32x32x16_bf16 v[128:143], a[64:67], a[0:3], v[128:143]
    v_add_u32 v173, 0, v165
    ds_read_b128 a[84:87], v173
    v_add_f32 v238, v238, v108
    v_exp_f32 v111, v111
    v_add_f32 v238, v238, v109
    v_add_f32 v238, v238, v110
    v_mfma_f32_32x32x16_bf16 v[128:143], a[68:71], a[4:7], v[128:143]
    v_add_u32 v174, 0, v166
    ds_read_b128 a[88:91], v174
    v_add_f32 v238, v238, v111
    v_max3_f32 v188, v112, v113, v114
    v_max3_f32 v189, v115, v116, v117
    v_max3_f32 v190, v118, v119, v120
    v_max3_f32 v191, v121, v122, v123
    s_waitcnt lgkmcnt(3)
    v_mfma_f32_32x32x16_bf16 v[128:143], a[72:75], a[8:11], v[128:143]
    v_add_u32 v175, 0, v167
    ds_read_b128 a[92:95], v175
    v_max3_f32 v192, v124, v125, v126
    v_max3_f32 v188, v188, v189, v127
    v_max3_f32 v190, v190, v191, v192
    v_max3_f32 v188, v188, v190, s51
    v_mul_f32 v230, s49, v188
    v_mfma_f32_32x32x16_bf16 v[128:143], a[76:79], a[12:15], v[128:143]
    ds_read_b128 a[64:67], v168 offset:256
    v_min_f32 v242, v242, v230
    v_fma_f32 v112, v112, s48, v230
    v_fma_f32 v113, v113, s48, v230
    v_exp_f32 v112, v112
    v_fma_f32 v114, v114, s48, v230
    s_waitcnt lgkmcnt(3)
    v_mfma_f32_32x32x16_bf16 v[128:143], a[80:83], a[16:19], v[128:143]
    ds_read_b128 a[68:71], v169 offset:256
    v_exp_f32 v113, v113
    v_fma_f32 v115, v115, s48, v230
    v_exp_f32 v114, v114
    v_fma_f32 v116, v116, s48, v230
    v_mfma_f32_32x32x16_bf16 v[128:143], a[84:87], a[20:23], v[128:143]
    ds_read_b128 a[72:75], v170 offset:256
    v_exp_f32 v115, v115
    v_add_f32 v239, v112, v113
    v_fma_f32 v117, v117, s48, v230
    v_exp_f32 v116, v116
    s_waitcnt lgkmcnt(3)
    v_mfma_f32_32x32x16_bf16 v[128:143], a[88:91], a[24:27], v[128:143]
    ds_read_b128 a[76:79], v171 offset:256
    v_add_f32 v239, v239, v114
    v_fma_f32 v118, v118, s48, v230
    v_exp_f32 v117, v117
    v_add_f32 v239, v239, v115
    v_fma_f32 v119, v119, s48, v230
    v_mfma_f32_32x32x16_bf16 v[128:143], a[92:95], a[28:31], v[128:143]
    ds_read_b128 a[80:83], v172 offset:256
    v_exp_f32 v118, v118
    v_add_f32 v239, v239, v116
    v_fma_f32 v120, v120, s48, v230
    v_exp_f32 v119, v119
    s_waitcnt lgkmcnt(3)
    v_mfma_f32_32x32x16_bf16 v[128:143], a[64:67], a[32:35], v[128:143]
    ds_read_b128 a[84:87], v173 offset:256
    v_add_f32 v239, v239, v117
    v_fma_f32 v121, v121, s48, v230
    v_exp_f32 v120, v120
    v_add_f32 v239, v239, v118
    v_fma_f32 v122, v122, s48, v230
    v_mfma_f32_32x32x16_bf16 v[128:143], a[68:71], a[36:39], v[128:143]
    ds_read_b128 a[88:91], v174 offset:256
    v_exp_f32 v121, v121
    v_add_f32 v239, v239, v119
    v_fma_f32 v123, v123, s48, v230
    v_exp_f32 v122, v122
    s_waitcnt lgkmcnt(3)
    v_mfma_f32_32x32x16_bf16 v[128:143], a[72:75], a[40:43], v[128:143]
    s_waitcnt vmcnt(24)
    s_barrier
    ds_read_b128 a[92:95], v175 offset:256
    s_add_u32 m0, s37, 0x20000
    s_nop 0
    buffer_load_dwordx4 v5, s[12:15], s28 offen nt lds
    v_add_f32 v239, v239, v120
    v_mfma_f32_32x32x16_bf16 v[128:143], a[76:79], a[44:47], v[128:143]
    ds_read_b128 a[64:67], v168 offset:16384
    s_add_u32 m0, s37, 0x21000
    s_nop 0
    buffer_load_dwordx4 v5, s[12:15], s32 offen nt lds
    v_fma_f32 v124, v124, s48, v230
    v_exp_f32 v123, v123
    s_waitcnt lgkmcnt(3)
    v_mfma_f32_32x32x16_bf16 v[128:143], a[80:83], a[48:51], v[128:143]
    ds_read_b128 a[68:71], v169 offset:16384
    s_add_u32 m0, s37, 0x22000
    s_nop 0
    buffer_load_dwordx4 v5, s[12:15], s24 offen nt lds
    v_add_f32 v239, v239, v121
    v_fma_f32 v125, v125, s48, v230
    v_exp_f32 v124, v124
    v_mfma_f32_32x32x16_bf16 v[128:143], a[84:87], a[52:55], v[128:143]
    ds_read_b128 a[72:75], v170 offset:16384
    s_add_u32 m0, s37, 0x23000
    s_nop 0
    buffer_load_dwordx4 v5, s[12:15], s33 offen nt lds
    v_add_f32 v239, v239, v122
    v_fma_f32 v126, v126, s48, v230
    v_exp_f32 v125, v125
    s_waitcnt lgkmcnt(3)
    v_mfma_f32_32x32x16_bf16 v[128:143], a[88:91], a[56:59], v[128:143]
    ds_read_b128 a[76:79], v171 offset:16384
    v_add_f32 v239, v239, v123
    v_fma_f32 v127, v127, s48, v230
    v_exp_f32 v126, v126
    v_add_f32 v239, v239, v124
    v_exp_f32 v127, v127
    v_mfma_f32_32x32x16_bf16 v[128:143], a[92:95], a[60:63], v[128:143]
    ds_read_b128 a[80:83], v172 offset:16384
    v_add_f32 v239, v239, v125
    v_add_f32 v239, v239, v126
    v_add_f32 v239, v239, v127
    s_waitcnt lgkmcnt(3)
    v_mfma_f32_32x32x16_bf16 v[144:159], a[64:67], a[0:3], v[144:159]
    ds_read_b128 a[84:87], v173 offset:16384
    v_mfma_f32_32x32x16_bf16 v[144:159], a[68:71], a[4:7], v[144:159]
    ds_read_b128 a[88:91], v174 offset:16384
    s_nop 2
    v_max3_f32 v188, v128, v129, v130
    v_max3_f32 v189, v131, v132, v133
    v_max3_f32 v190, v134, v135, v136
    v_max3_f32 v191, v137, v138, v139
    v_max3_f32 v192, v140, v141, v142
    v_max3_f32 v188, v188, v189, v143
    s_waitcnt lgkmcnt(3)
    v_mfma_f32_32x32x16_bf16 v[144:159], a[72:75], a[8:11], v[144:159]
    ds_read_b128 a[92:95], v175 offset:16384
    v_max3_f32 v190, v190, v191, v192
    v_max3_f32 v188, v188, v190, s51
    v_mul_f32 v231, s49, v188
    v_min_f32 v242, v242, v231
    v_fma_f32 v128, v128, s48, v231
    v_fma_f32 v129, v129, s48, v231
    v_mfma_f32_32x32x16_bf16 v[144:159], a[76:79], a[12:15], v[144:159]
    ds_read_b128 a[64:67], v168 offset:16640
    v_exp_f32 v128, v128
    v_fma_f32 v130, v130, s48, v231
    v_exp_f32 v129, v129
    v_fma_f32 v131, v131, s48, v231
    s_waitcnt lgkmcnt(3)
    v_mfma_f32_32x32x16_bf16 v[144:159], a[80:83], a[16:19], v[144:159]
    ds_read_b128 a[68:71], v169 offset:16640
    v_exp_f32 v130, v130
    v_fma_f32 v132, v132, s48, v231
    v_exp_f32 v131, v131
    v_add_f32 v240, v128, v129
    v_mfma_f32_32x32x16_bf16 v[144:159], a[84:87], a[20:23], v[144:159]
    ds_read_b128 a[72:75], v170 offset:16640
    v_fma_f32 v133, v133, s48, v231
    v_exp_f32 v132, v132
    v_add_f32 v240, v240, v130
    v_fma_f32 v134, v134, s48, v231
    v_exp_f32 v133, v133
    s_waitcnt lgkmcnt(3)
    v_mfma_f32_32x32x16_bf16 v[144:159], a[88:91], a[24:27], v[144:159]
    ds_read_b128 a[76:79], v171 offset:16640
    v_add_f32 v240, v240, v131
    v_fma_f32 v135, v135, s48, v231
    v_exp_f32 v134, v134
    v_add_f32 v240, v240, v132
    v_fma_f32 v136, v136, s48, v231
    v_mfma_f32_32x32x16_bf16 v[144:159], a[92:95], a[28:31], v[144:159]
    ds_read_b128 a[80:83], v172 offset:16640
    v_exp_f32 v135, v135
    v_add_f32 v240, v240, v133
    v_fma_f32 v137, v137, s48, v231
    v_exp_f32 v136, v136
    s_waitcnt lgkmcnt(3)
    v_mfma_f32_32x32x16_bf16 v[144:159], a[64:67], a[32:35], v[144:159]
    ds_read_b128 a[84:87], v173 offset:16640
    v_add_f32 v240, v240, v134
    v_fma_f32 v138, v138, s48, v231
    v_exp_f32 v137, v137
    v_add_f32 v240, v240, v135
    v_fma_f32 v139, v139, s48, v231
    v_mfma_f32_32x32x16_bf16 v[144:159], a[68:71], a[36:39], v[144:159]
    ds_read_b128 a[88:91], v174 offset:16640
    v_exp_f32 v138, v138
    v_add_f32 v240, v240, v136
    v_fma_f32 v140, v140, s48, v231
    v_exp_f32 v139, v139
    s_waitcnt lgkmcnt(3)
    v_mfma_f32_32x32x16_bf16 v[144:159], a[72:75], a[40:43], v[144:159]
    s_waitcnt vmcnt(24)
    s_barrier
    ds_read_b128 a[92:95], v175 offset:16640
    s_add_u32 m0, s37, 0
    s_nop 0
    buffer_load_dwordx4 v5, s[12:15], s29 offen nt lds
    v_add_f32 v240, v240, v137
    v_mfma_f32_32x32x16_bf16 v[144:159], a[76:79], a[44:47], v[144:159]
    v_add_u32 v252, 0x8000, v246
    ds_read_b64_tr_b16 a[64:65], v252
    ds_read_b64_tr_b16 a[66:67], v252 offset:2048
    s_add_u32 m0, s37, 0x1000
    s_nop 0
    buffer_load_dwordx4 v5, s[12:15], s25 offen nt lds
    v_fma_f32 v141, v141, s48, v231
    s_waitcnt lgkmcnt(4)
    v_mfma_f32_32x32x16_bf16 v[144:159], a[80:83], a[48:51], v[144:159]
    v_add_u32 v253, 0x8000, v247
    ds_read_b64_tr_b16 a[68:69], v253
    ds_read_b64_tr_b16 a[70:71], v253 offset:2048
    s_add_u32 m0, s37, 0x2000
    s_nop 0
    buffer_load_dwordx4 v5, s[12:15], s34 offen nt lds
    v_exp_f32 v140, v140
    v_mfma_f32_32x32x16_bf16 v[144:159], a[84:87], a[52:55], v[144:159]
    v_add_u32 v254, 0x8000, v248
    ds_read_b64_tr_b16 a[72:73], v254
    ds_read_b64_tr_b16 a[74:75], v254 offset:2048
    s_add_u32 m0, s37, 0x3000
    s_nop 0
    buffer_load_dwordx4 v5, s[12:15], s30 offen nt lds
    v_add_f32 v240, v240, v138
    s_waitcnt lgkmcnt(6)
    v_mfma_f32_32x32x16_bf16 v[144:159], a[88:91], a[56:59], v[144:159]
    v_add_u32 v255, 0x8000, v249
    ds_read_b64_tr_b16 a[76:77], v255
    ds_read_b64_tr_b16 a[78:79], v255 offset:2048
    v_fma_f32 v142, v142, s48, v231
    v_exp_f32 v141, v141
    v_add_f32 v240, v240, v139
    v_mfma_f32_32x32x16_bf16 v[144:159], a[92:95], a[60:63], v[144:159]
    ds_read_b64_tr_b16 a[80:81], v252 offset:4096
    ds_read_b64_tr_b16 a[82:83], v252 offset:6144
    v_fma_f32 v143, v143, s48, v231
    v_exp_f32 v142, v142
    v_add_f32 v240, v240, v140
    v_exp_f32 v143, v143
    v_add_f32 v240, v240, v141
    v_add_f32 v240, v240, v142
    v_add_f32 v240, v240, v143
    s_nop 2
    v_max3_f32 v188, v144, v145, v146
    v_max3_f32 v189, v147, v148, v149
    v_max3_f32 v190, v150, v151, v152
    v_max3_f32 v191, v153, v154, v155
    v_max3_f32 v192, v156, v157, v158
    v_max3_f32 v188, v188, v189, v159
    v_max3_f32 v190, v190, v191, v192
    v_max3_f32 v188, v188, v190, s51
    v_mul_f32 v232, s49, v188
    v_min_f32 v242, v242, v232
    v_fma_f32 v144, v144, s48, v232
    v_fma_f32 v145, v145, s48, v232
    v_exp_f32 v144, v144
    v_fma_f32 v146, v146, s48, v232
    v_exp_f32 v145, v145
    v_fma_f32 v147, v147, s48, v232
    v_exp_f32 v146, v146
    v_fma_f32 v148, v148, s48, v232
    v_exp_f32 v147, v147
    v_add_f32 v241, v144, v145
    v_fma_f32 v149, v149, s48, v232
    v_exp_f32 v148, v148
    v_add_f32 v241, v241, v146
    v_fma_f32 v150, v150, s48, v232
    v_exp_f32 v149, v149
    v_add_f32 v241, v241, v147
    v_fma_f32 v151, v151, s48, v232
    v_exp_f32 v150, v150
    v_add_f32 v241, v241, v148
    v_fma_f32 v152, v152, s48, v232
    v_exp_f32 v151, v151
    v_add_f32 v241, v241, v149
    v_fma_f32 v153, v153, s48, v232
    v_exp_f32 v152, v152
    v_add_f32 v241, v241, v150
    v_fma_f32 v154, v154, s48, v232
    v_exp_f32 v153, v153
    v_add_f32 v241, v241, v151
    v_fma_f32 v155, v155, s48, v232
    v_exp_f32 v154, v154
    v_add_f32 v241, v241, v152
    v_fma_f32 v156, v156, s48, v232
    v_exp_f32 v155, v155
    v_add_f32 v241, v241, v153
    v_fma_f32 v157, v157, s48, v232
    v_exp_f32 v156, v156
    v_add_f32 v241, v241, v154
    v_fma_f32 v158, v158, s48, v232
    v_exp_f32 v157, v157
    v_add_f32 v241, v241, v155
    v_fma_f32 v159, v159, s48, v232
    v_exp_f32 v158, v158
    v_add_f32 v241, v241, v156
    v_exp_f32 v159, v159
    v_add_f32 v241, v241, v157
    v_add_f32 v241, v241, v158
    v_add_f32 v241, v241, v159
    v_mov_b32 v244, v242
    s_nop 1
    v_permlane32_swap_b32 v242, v244
    v_min_f32 v242, v242, v244
    v_sub_f32 v224, v242, v224
    v_sub_f32 v225, v242, v225
    v_sub_f32 v226, v242, v226
    v_sub_f32 v227, v242, v227
    v_sub_f32 v228, v242, v228
    v_sub_f32 v229, v242, v229
    v_sub_f32 v230, v242, v230
    v_sub_f32 v231, v242, v231
    v_sub_f32 v232, v242, v232
    v_exp_f32 v224, v224
    v_exp_f32 v225, v225
    v_exp_f32 v226, v226
    v_exp_f32 v227, v227
    v_exp_f32 v228, v228
    v_exp_f32 v229, v229
    v_exp_f32 v230, v230
    v_exp_f32 v231, v231
    v_exp_f32 v232, v232
    v_mul_f32 v243, v224, v233
    v_fma_f32 v243, v225, v234, v243
    v_fma_f32 v243, v226, v235, v243
    v_fma_f32 v243, v227, v236, v243
    v_fma_f32 v243, v228, v237, v243
    v_fma_f32 v243, v229, v238, v243
    v_fma_f32 v243, v230, v239, v243
    v_fma_f32 v243, v231, v240, v243
    v_fma_f32 v243, v232, v241, v243
    v_mov_b32 v244, v243
    s_nop 1
    v_permlane32_swap_b32 v243, v244
    v_add_f32 v243, v243, v244
    v_rcp_f32 v243, v243
    s_nop 0
    v_mul_f32 v224, v224, v243
    v_mul_f32 v225, v225, v243
    v_mul_f32 v226, v226, v243
    v_mul_f32 v227, v227, v243
    v_mul_f32 v228, v228, v243
    v_mul_f32 v229, v229, v243
    v_mul_f32 v230, v230, v243
    v_mul_f32 v231, v231, v243
    v_mul_f32 v232, v232, v243
    v_mul_f32 v16, v16, v224
    v_mul_f32 v17, v17, v224
    v_mul_f32 v18, v18, v224
    v_mul_f32 v19, v19, v224
    v_mul_f32 v20, v20, v224
    v_mul_f32 v21, v21, v224
    v_mul_f32 v22, v22, v224
    v_mul_f32 v23, v23, v224
    v_cvt_pk_bf16_f32 v16, v16, v17
    v_cvt_pk_bf16_f32 v17, v18, v19
    v_cvt_pk_bf16_f32 v18, v20, v21
    v_cvt_pk_bf16_f32 v19, v22, v23
    v_mul_f32 v24, v24, v224
    v_mul_f32 v25, v25, v224
    v_mul_f32 v26, v26, v224
    v_mul_f32 v27, v27, v224
    v_mul_f32 v28, v28, v224
    v_mul_f32 v29, v29, v224
    v_mul_f32 v30, v30, v224
    v_mul_f32 v31, v31, v224
    v_cvt_pk_bf16_f32 v20, v24, v25
    v_cvt_pk_bf16_f32 v21, v26, v27
    v_cvt_pk_bf16_f32 v22, v28, v29
    v_cvt_pk_bf16_f32 v23, v30, v31
    s_waitcnt lgkmcnt(6)
    v_mfma_f32_32x32x16_bf16 v[160:175], a[64:67], v[16:19], 0
    ds_read_b64_tr_b16 a[84:85], v253 offset:4096
    ds_read_b64_tr_b16 a[86:87], v253 offset:6144
    v_mul_f32 v32, v32, v225
    v_mul_f32 v33, v33, v225
    v_mul_f32 v34, v34, v225
    v_mul_f32 v35, v35, v225
    v_mfma_f32_32x32x16_bf16 v[176:191], a[68:71], v[16:19], 0
    ds_read_b64_tr_b16 a[88:89], v254 offset:4096
    ds_read_b64_tr_b16 a[90:91], v254 offset:6144
    v_mul_f32 v36, v36, v225
    v_mul_f32 v37, v37, v225
    v_mul_f32 v38, v38, v225
    v_mul_f32 v39, v39, v225
    s_waitcnt lgkmcnt(6)
    v_mfma_f32_32x32x16_bf16 v[192:207], a[72:75], v[16:19], 0
    ds_read_b64_tr_b16 a[92:93], v255 offset:4096
    ds_read_b64_tr_b16 a[94:95], v255 offset:6144
    v_cvt_pk_bf16_f32 v24, v32, v33
    v_cvt_pk_bf16_f32 v25, v34, v35
    v_cvt_pk_bf16_f32 v26, v36, v37
    v_cvt_pk_bf16_f32 v27, v38, v39
    v_mfma_f32_32x32x16_bf16 v[208:223], a[76:79], v[16:19], 0
    ds_read_b64_tr_b16 a[64:65], v252 offset:8192
    ds_read_b64_tr_b16 a[66:67], v252 offset:10240
    v_mul_f32 v40, v40, v225
    v_mul_f32 v41, v41, v225
    v_mul_f32 v42, v42, v225
    v_mul_f32 v43, v43, v225
    s_waitcnt lgkmcnt(6)
    v_mfma_f32_32x32x16_bf16 v[160:175], a[80:83], v[20:23], v[160:175]
    ds_read_b64_tr_b16 a[68:69], v253 offset:8192
    ds_read_b64_tr_b16 a[70:71], v253 offset:10240
    v_mul_f32 v44, v44, v225
    v_mul_f32 v45, v45, v225
    v_mul_f32 v46, v46, v225
    v_mul_f32 v47, v47, v225
    v_mfma_f32_32x32x16_bf16 v[176:191], a[84:87], v[20:23], v[176:191]
    ds_read_b64_tr_b16 a[72:73], v254 offset:8192
    ds_read_b64_tr_b16 a[74:75], v254 offset:10240
    v_cvt_pk_bf16_f32 v28, v40, v41
    v_cvt_pk_bf16_f32 v29, v42, v43
    v_cvt_pk_bf16_f32 v30, v44, v45
    v_cvt_pk_bf16_f32 v31, v46, v47
    s_waitcnt lgkmcnt(6)
    v_mfma_f32_32x32x16_bf16 v[192:207], a[88:91], v[20:23], v[192:207]
    ds_read_b64_tr_b16 a[76:77], v255 offset:8192
    ds_read_b64_tr_b16 a[78:79], v255 offset:10240
    v_mfma_f32_32x32x16_bf16 v[208:223], a[92:95], v[20:23], v[208:223]
    ds_read_b64_tr_b16 a[80:81], v252 offset:12288
    ds_read_b64_tr_b16 a[82:83], v252 offset:14336
    v_mul_f32 v48, v48, v226
    v_mul_f32 v49, v49, v226
    v_mul_f32 v50, v50, v226
    v_mul_f32 v51, v51, v226
    s_waitcnt lgkmcnt(6)
    v_mfma_f32_32x32x16_bf16 v[160:175], a[64:67], v[24:27], v[160:175]
    ds_read_b64_tr_b16 a[84:85], v253 offset:12288
    ds_read_b64_tr_b16 a[86:87], v253 offset:14336
    v_mul_f32 v52, v52, v226
    v_mul_f32 v53, v53, v226
    v_mul_f32 v54, v54, v226
    v_mul_f32 v55, v55, v226
    v_mfma_f32_32x32x16_bf16 v[176:191], a[68:71], v[24:27], v[176:191]
    ds_read_b64_tr_b16 a[88:89], v254 offset:12288
    ds_read_b64_tr_b16 a[90:91], v254 offset:14336
    v_cvt_pk_bf16_f32 v32, v48, v49
    v_cvt_pk_bf16_f32 v33, v50, v51
    v_cvt_pk_bf16_f32 v34, v52, v53
    v_cvt_pk_bf16_f32 v35, v54, v55
    s_waitcnt lgkmcnt(6)
    v_mfma_f32_32x32x16_bf16 v[192:207], a[72:75], v[24:27], v[192:207]
    s_waitcnt vmcnt(22)
    s_barrier
    ds_read_b64_tr_b16 a[92:93], v255 offset:12288
    ds_read_b64_tr_b16 a[94:95], v255 offset:14336
    s_add_u32 m0, s37, 0x4000
    s_nop 0
    buffer_load_dwordx4 v5, s[12:15], s26 offen nt lds
    v_mfma_f32_32x32x16_bf16 v[208:223], a[76:79], v[24:27], v[208:223]
    s_and_b32 s54, s44, 0x2000
    s_add_u32 s54, s54, 0xc000
    v_add_u32 v252, s54, v246
    ds_read_b64_tr_b16 a[64:65], v252
    ds_read_b64_tr_b16 a[66:67], v252 offset:2048
    s_add_u32 m0, s37, 0x5000
    s_nop 0
    buffer_load_dwordx4 v5, s[12:15], s35 offen nt lds
    s_waitcnt lgkmcnt(6)
    v_mfma_f32_32x32x16_bf16 v[160:175], a[80:83], v[28:31], v[160:175]
    v_add_u32 v253, s54, v247
    ds_read_b64_tr_b16 a[68:69], v253
    ds_read_b64_tr_b16 a[70:71], v253 offset:2048
    s_add_u32 m0, s37, 0x6000
    s_nop 0
    buffer_load_dwordx4 v5, s[12:15], s31 offen nt lds
    v_mfma_f32_32x32x16_bf16 v[176:191], a[84:87], v[28:31], v[176:191]
    v_add_u32 v254, s54, v248
    ds_read_b64_tr_b16 a[72:73], v254
    ds_read_b64_tr_b16 a[74:75], v254 offset:2048
    s_add_u32 m0, s37, 0x7000
    s_nop 0
    buffer_load_dwordx4 v5, s[12:15], s27 offen nt lds
    s_waitcnt lgkmcnt(6)
    v_mfma_f32_32x32x16_bf16 v[192:207], a[88:91], v[28:31], v[192:207]
    v_add_u32 v255, s54, v249
    ds_read_b64_tr_b16 a[76:77], v255
    ds_read_b64_tr_b16 a[78:79], v255 offset:2048
    v_add_u32 v5, 0x80, v5
    s_add_u32 m0, s37, 0x8000
    s_nop 0
    buffer_load_dwordx4 v5, s[12:15], s28 offen nt lds
    v_mfma_f32_32x32x16_bf16 v[208:223], a[92:95], v[28:31], v[208:223]
    ds_read_b64_tr_b16 a[80:81], v252 offset:4096
    ds_read_b64_tr_b16 a[82:83], v252 offset:6144
    s_add_u32 m0, s37, 0x9000
    s_nop 0
    buffer_load_dwordx4 v5, s[12:15], s32 offen nt lds
    v_mul_f32 v56, v56, v226
    s_waitcnt lgkmcnt(6)
    v_mfma_f32_32x32x16_bf16 v[160:175], a[64:67], v[32:35], v[160:175]
    ds_read_b64_tr_b16 a[84:85], v253 offset:4096
    ds_read_b64_tr_b16 a[86:87], v253 offset:6144
    v_mul_f32 v57, v57, v226
    v_mul_f32 v58, v58, v226
    v_mul_f32 v59, v59, v226
    v_mul_f32 v60, v60, v226
    v_mfma_f32_32x32x16_bf16 v[176:191], a[68:71], v[32:35], v[176:191]
    ds_read_b64_tr_b16 a[88:89], v254 offset:4096
    ds_read_b64_tr_b16 a[90:91], v254 offset:6144
    v_mul_f32 v61, v61, v226
    v_mul_f32 v62, v62, v226
    v_mul_f32 v63, v63, v226
    v_cvt_pk_bf16_f32 v36, v56, v57
    s_waitcnt lgkmcnt(6)
    v_mfma_f32_32x32x16_bf16 v[192:207], a[72:75], v[32:35], v[192:207]
    ds_read_b64_tr_b16 a[92:93], v255 offset:4096
    ds_read_b64_tr_b16 a[94:95], v255 offset:6144
    v_cvt_pk_bf16_f32 v37, v58, v59
    v_cvt_pk_bf16_f32 v38, v60, v61
    v_cvt_pk_bf16_f32 v39, v62, v63
    v_mul_f32 v64, v64, v227
    v_mfma_f32_32x32x16_bf16 v[208:223], a[76:79], v[32:35], v[208:223]
    v_add_u32 v252, 0x10000, v246
    ds_read_b64_tr_b16 a[64:65], v252
    ds_read_b64_tr_b16 a[66:67], v252 offset:2048
    v_mul_f32 v65, v65, v227
    v_mul_f32 v66, v66, v227
    v_mul_f32 v67, v67, v227
    s_waitcnt lgkmcnt(6)
    v_mfma_f32_32x32x16_bf16 v[160:175], a[80:83], v[36:39], v[160:175]
    v_add_u32 v253, 0x10000, v247
    ds_read_b64_tr_b16 a[68:69], v253
    ds_read_b64_tr_b16 a[70:71], v253 offset:2048
    v_mul_f32 v68, v68, v227
    v_mul_f32 v69, v69, v227
    v_mul_f32 v70, v70, v227
    v_mfma_f32_32x32x16_bf16 v[176:191], a[84:87], v[36:39], v[176:191]
    v_add_u32 v254, 0x10000, v248
    ds_read_b64_tr_b16 a[72:73], v254
    ds_read_b64_tr_b16 a[74:75], v254 offset:2048
    v_mul_f32 v71, v71, v227
    v_cvt_pk_bf16_f32 v40, v64, v65
    v_cvt_pk_bf16_f32 v41, v66, v67
    s_waitcnt lgkmcnt(6)
    v_mfma_f32_32x32x16_bf16 v[192:207], a[88:91], v[36:39], v[192:207]
    v_add_u32 v255, 0x10000, v249
    ds_read_b64_tr_b16 a[76:77], v255
    ds_read_b64_tr_b16 a[78:79], v255 offset:2048
    v_cvt_pk_bf16_f32 v42, v68, v69
    v_cvt_pk_bf16_f32 v43, v70, v71
    v_mul_f32 v72, v72, v227
    v_mfma_f32_32x32x16_bf16 v[208:223], a[92:95], v[36:39], v[208:223]
    ds_read_b64_tr_b16 a[80:81], v252 offset:4096
    ds_read_b64_tr_b16 a[82:83], v252 offset:6144
    v_mul_f32 v73, v73, v227
    v_mul_f32 v74, v74, v227
    v_mul_f32 v75, v75, v227
    v_mul_f32 v76, v76, v227
    s_waitcnt lgkmcnt(6)
    v_mfma_f32_32x32x16_bf16 v[160:175], a[64:67], v[40:43], v[160:175]
    ds_read_b64_tr_b16 a[84:85], v253 offset:4096
    ds_read_b64_tr_b16 a[86:87], v253 offset:6144
    v_mul_f32 v77, v77, v227
    v_mul_f32 v78, v78, v227
    v_mul_f32 v79, v79, v227
    v_cvt_pk_bf16_f32 v44, v72, v73
    v_mfma_f32_32x32x16_bf16 v[176:191], a[68:71], v[40:43], v[176:191]
    ds_read_b64_tr_b16 a[88:89], v254 offset:4096
    ds_read_b64_tr_b16 a[90:91], v254 offset:6144
    v_cvt_pk_bf16_f32 v45, v74, v75
    v_cvt_pk_bf16_f32 v46, v76, v77
    v_cvt_pk_bf16_f32 v47, v78, v79
    v_mul_f32 v80, v80, v228
    s_waitcnt lgkmcnt(6)
    v_mfma_f32_32x32x16_bf16 v[192:207], a[72:75], v[40:43], v[192:207]
    s_waitcnt vmcnt(22)
    s_barrier
    ds_read_b64_tr_b16 a[92:93], v255 offset:4096
    ds_read_b64_tr_b16 a[94:95], v255 offset:6144
    s_add_u32 m0, s37, 0xa000
    s_nop 0
    buffer_load_dwordx4 v5, s[12:15], s24 offen nt lds
    v_mfma_f32_32x32x16_bf16 v[208:223], a[76:79], v[40:43], v[208:223]
    s_and_b32 s54, s45, 0x2000
    s_add_u32 s54, s54, 0x12000
    v_add_u32 v252, s54, v246
    ds_read_b64_tr_b16 a[64:65], v252
    ds_read_b64_tr_b16 a[66:67], v252 offset:2048
    s_add_u32 m0, s37, 0xb000
    s_nop 0
    buffer_load_dwordx4 v5, s[12:15], s33 offen nt lds
    s_waitcnt lgkmcnt(6)
    v_mfma_f32_32x32x16_bf16 v[160:175], a[80:83], v[44:47], v[160:175]
    v_add_u32 v253, s54, v247
    ds_read_b64_tr_b16 a[68:69], v253
    ds_read_b64_tr_b16 a[70:71], v253 offset:2048
    s_add_u32 m0, s37, 0xc000
    s_nop 0
    buffer_load_dwordx4 v5, s[12:15], s29 offen nt lds
    v_mfma_f32_32x32x16_bf16 v[176:191], a[84:87], v[44:47], v[176:191]
    v_add_u32 v254, s54, v248
    ds_read_b64_tr_b16 a[72:73], v254
    ds_read_b64_tr_b16 a[74:75], v254 offset:2048
    s_add_u32 m0, s37, 0xd000
    s_nop 0
    buffer_load_dwordx4 v5, s[12:15], s25 offen nt lds
    s_waitcnt lgkmcnt(6)
    v_mfma_f32_32x32x16_bf16 v[192:207], a[88:91], v[44:47], v[192:207]
    v_add_u32 v255, s54, v249
    ds_read_b64_tr_b16 a[76:77], v255
    ds_read_b64_tr_b16 a[78:79], v255 offset:2048
    s_add_u32 m0, s37, 0xe000
    s_nop 0
    buffer_load_dwordx4 v5, s[12:15], s34 offen nt lds
    v_mfma_f32_32x32x16_bf16 v[208:223], a[92:95], v[44:47], v[208:223]
    ds_read_b64_tr_b16 a[80:81], v252 offset:4096
    ds_read_b64_tr_b16 a[82:83], v252 offset:6144
    s_add_u32 m0, s37, 0xf000
    s_nop 0
    buffer_load_dwordx4 v5, s[12:15], s30 offen nt lds
    v_mul_f32 v81, v81, v228
    v_mul_f32 v82, v82, v228
    v_mul_f32 v83, v83, v228
    v_mul_f32 v84, v84, v228
    v_mul_f32 v85, v85, v228
    v_mul_f32 v86, v86, v228
    v_mul_f32 v87, v87, v228
    v_cvt_pk_bf16_f32 v48, v80, v81
    v_cvt_pk_bf16_f32 v49, v82, v83
    v_cvt_pk_bf16_f32 v50, v84, v85
    v_cvt_pk_bf16_f32 v51, v86, v87
    s_waitcnt lgkmcnt(6)
    s_nop 0
    v_mfma_f32_32x32x16_bf16 v[160:175], a[64:67], v[48:51], v[160:175]
    ds_read_b64_tr_b16 a[84:85], v253 offset:4096
    ds_read_b64_tr_b16 a[86:87], v253 offset:6144
    v_mul_f32 v88, v88, v228
    v_mul_f32 v89, v89, v228
    v_mul_f32 v90, v90, v228
    v_mul_f32 v91, v91, v228
    v_mfma_f32_32x32x16_bf16 v[176:191], a[68:71], v[48:51], v[176:191]
    ds_read_b64_tr_b16 a[88:89], v254 offset:4096
    ds_read_b64_tr_b16 a[90:91], v254 offset:6144
    v_mul_f32 v92, v92, v228
    v_mul_f32 v93, v93, v228
    v_mul_f32 v94, v94, v228
    v_mul_f32 v95, v95, v228
    s_waitcnt lgkmcnt(6)
    v_mfma_f32_32x32x16_bf16 v[192:207], a[72:75], v[48:51], v[192:207]
    ds_read_b64_tr_b16 a[92:93], v255 offset:4096
    ds_read_b64_tr_b16 a[94:95], v255 offset:6144
    v_cvt_pk_bf16_f32 v52, v88, v89
    v_cvt_pk_bf16_f32 v53, v90, v91
    v_cvt_pk_bf16_f32 v54, v92, v93
    v_cvt_pk_bf16_f32 v55, v94, v95
    v_mfma_f32_32x32x16_bf16 v[208:223], a[76:79], v[48:51], v[208:223]
    v_add_u32 v252, 0x16000, v246
    ds_read_b64_tr_b16 a[64:65], v252
    ds_read_b64_tr_b16 a[66:67], v252 offset:2048
    v_mul_f32 v96, v96, v229
    v_mul_f32 v97, v97, v229
    v_mul_f32 v98, v98, v229
    s_waitcnt lgkmcnt(6)
    v_mfma_f32_32x32x16_bf16 v[160:175], a[80:83], v[52:55], v[160:175]
    v_add_u32 v253, 0x16000, v247
    ds_read_b64_tr_b16 a[68:69], v253
    ds_read_b64_tr_b16 a[70:71], v253 offset:2048
    v_mul_f32 v99, v99, v229
    v_mul_f32 v100, v100, v229
    v_mul_f32 v101, v101, v229
    v_mfma_f32_32x32x16_bf16 v[176:191], a[84:87], v[52:55], v[176:191]
    v_add_u32 v254, 0x16000, v248
    ds_read_b64_tr_b16 a[72:73], v254
    ds_read_b64_tr_b16 a[74:75], v254 offset:2048
    v_mul_f32 v102, v102, v229
    v_mul_f32 v103, v103, v229
    v_cvt_pk_bf16_f32 v56, v96, v97
    s_waitcnt lgkmcnt(6)
    v_mfma_f32_32x32x16_bf16 v[192:207], a[88:91], v[52:55], v[192:207]
    v_add_u32 v255, 0x16000, v249
    ds_read_b64_tr_b16 a[76:77], v255
    ds_read_b64_tr_b16 a[78:79], v255 offset:2048
    v_cvt_pk_bf16_f32 v57, v98, v99
    v_cvt_pk_bf16_f32 v58, v100, v101
    v_cvt_pk_bf16_f32 v59, v102, v103
    v_mfma_f32_32x32x16_bf16 v[208:223], a[92:95], v[52:55], v[208:223]
    ds_read_b64_tr_b16 a[80:81], v252 offset:4096
    ds_read_b64_tr_b16 a[82:83], v252 offset:6144
    v_mul_f32 v104, v104, v229
    v_mul_f32 v105, v105, v229
    v_mul_f32 v106, v106, v229
    v_mul_f32 v107, v107, v229
    s_waitcnt lgkmcnt(6)
    v_mfma_f32_32x32x16_bf16 v[160:175], a[64:67], v[56:59], v[160:175]
    ds_read_b64_tr_b16 a[84:85], v253 offset:4096
    ds_read_b64_tr_b16 a[86:87], v253 offset:6144
    v_mul_f32 v108, v108, v229
    v_mul_f32 v109, v109, v229
    v_mul_f32 v110, v110, v229
    v_mul_f32 v111, v111, v229
    v_mfma_f32_32x32x16_bf16 v[176:191], a[68:71], v[56:59], v[176:191]
    ds_read_b64_tr_b16 a[88:89], v254 offset:4096
    ds_read_b64_tr_b16 a[90:91], v254 offset:6144
    v_cvt_pk_bf16_f32 v60, v104, v105
    v_cvt_pk_bf16_f32 v61, v106, v107
    v_cvt_pk_bf16_f32 v62, v108, v109
    v_cvt_pk_bf16_f32 v63, v110, v111
    s_waitcnt lgkmcnt(6)
    v_mfma_f32_32x32x16_bf16 v[192:207], a[72:75], v[56:59], v[192:207]
    s_waitcnt vmcnt(22)
    s_barrier
    ds_read_b64_tr_b16 a[92:93], v255 offset:4096
    ds_read_b64_tr_b16 a[94:95], v255 offset:6144
    s_add_u32 m0, s37, 0x10000
    s_nop 0
    buffer_load_dwordx4 v5, s[12:15], s26 offen nt lds
    v_mfma_f32_32x32x16_bf16 v[208:223], a[76:79], v[56:59], v[208:223]
    s_and_b32 s54, s46, 0x2000
    s_add_u32 s54, s54, 0x18000
    v_add_u32 v252, s54, v246
    ds_read_b64_tr_b16 a[64:65], v252
    ds_read_b64_tr_b16 a[66:67], v252 offset:2048
    s_add_u32 m0, s37, 0x11000
    s_nop 0
    buffer_load_dwordx4 v5, s[12:15], s35 offen nt lds
    s_waitcnt lgkmcnt(6)
    v_mfma_f32_32x32x16_bf16 v[160:175], a[80:83], v[60:63], v[160:175]
    v_add_u32 v253, s54, v247
    ds_read_b64_tr_b16 a[68:69], v253
    ds_read_b64_tr_b16 a[70:71], v253 offset:2048
    s_add_u32 m0, s37, 0x12000
    s_nop 0
    buffer_load_dwordx4 v5, s[12:15], s31 offen nt lds
    v_mfma_f32_32x32x16_bf16 v[176:191], a[84:87], v[60:63], v[176:191]
    v_add_u32 v254, s54, v248
    ds_read_b64_tr_b16 a[72:73], v254
    ds_read_b64_tr_b16 a[74:75], v254 offset:2048
    s_add_u32 m0, s37, 0x13000
    s_nop 0
    buffer_load_dwordx4 v5, s[12:15], s27 offen nt lds
    s_waitcnt lgkmcnt(6)
    v_mfma_f32_32x32x16_bf16 v[192:207], a[88:91], v[60:63], v[192:207]
    v_add_u32 v255, s54, v249
    ds_read_b64_tr_b16 a[76:77], v255
    ds_read_b64_tr_b16 a[78:79], v255 offset:2048
    v_mul_f32 v112, v112, v230
    v_mul_f32 v113, v113, v230
    v_mul_f32 v114, v114, v230
    v_mfma_f32_32x32x16_bf16 v[208:223], a[92:95], v[60:63], v[208:223]
    ds_read_b64_tr_b16 a[80:81], v252 offset:4096
    ds_read_b64_tr_b16 a[82:83], v252 offset:6144
    v_mul_f32 v115, v115, v230
    v_mul_f32 v116, v116, v230
    v_mul_f32 v117, v117, v230
    v_mul_f32 v118, v118, v230
    v_mul_f32 v119, v119, v230
    v_cvt_pk_bf16_f32 v64, v112, v113
    v_cvt_pk_bf16_f32 v65, v114, v115
    v_cvt_pk_bf16_f32 v66, v116, v117
    v_cvt_pk_bf16_f32 v67, v118, v119
    s_waitcnt lgkmcnt(6)
    s_nop 0
    v_mfma_f32_32x32x16_bf16 v[160:175], a[64:67], v[64:67], v[160:175]
    ds_read_b64_tr_b16 a[84:85], v253 offset:4096
    ds_read_b64_tr_b16 a[86:87], v253 offset:6144
    v_mul_f32 v120, v120, v230
    v_mul_f32 v121, v121, v230
    v_mul_f32 v122, v122, v230
    v_mul_f32 v123, v123, v230
    v_mfma_f32_32x32x16_bf16 v[176:191], a[68:71], v[64:67], v[176:191]
    ds_read_b64_tr_b16 a[88:89], v254 offset:4096
    ds_read_b64_tr_b16 a[90:91], v254 offset:6144
    v_mul_f32 v124, v124, v230
    v_mul_f32 v125, v125, v230
    v_mul_f32 v126, v126, v230
    v_mul_f32 v127, v127, v230
    s_waitcnt lgkmcnt(6)
    v_mfma_f32_32x32x16_bf16 v[192:207], a[72:75], v[64:67], v[192:207]
    ds_read_b64_tr_b16 a[92:93], v255 offset:4096
    ds_read_b64_tr_b16 a[94:95], v255 offset:6144
    v_cvt_pk_bf16_f32 v68, v120, v121
    v_cvt_pk_bf16_f32 v69, v122, v123
    v_cvt_pk_bf16_f32 v70, v124, v125
    v_cvt_pk_bf16_f32 v71, v126, v127
    v_mfma_f32_32x32x16_bf16 v[208:223], a[76:79], v[64:67], v[208:223]
    v_add_u32 v252, 0x1c000, v246
    ds_read_b64_tr_b16 a[64:65], v252
    ds_read_b64_tr_b16 a[66:67], v252 offset:2048
    v_mul_f32 v128, v128, v231
    v_mul_f32 v129, v129, v231
    v_mul_f32 v130, v130, v231
    s_waitcnt lgkmcnt(6)
    v_mfma_f32_32x32x16_bf16 v[160:175], a[80:83], v[68:71], v[160:175]
    v_add_u32 v253, 0x1c000, v247
    ds_read_b64_tr_b16 a[68:69], v253
    ds_read_b64_tr_b16 a[70:71], v253 offset:2048
    v_mul_f32 v131, v131, v231
    v_mul_f32 v132, v132, v231
    v_mul_f32 v133, v133, v231
    v_mfma_f32_32x32x16_bf16 v[176:191], a[84:87], v[68:71], v[176:191]
    v_add_u32 v254, 0x1c000, v248
    ds_read_b64_tr_b16 a[72:73], v254
    ds_read_b64_tr_b16 a[74:75], v254 offset:2048
    v_mul_f32 v134, v134, v231
    v_mul_f32 v135, v135, v231
    v_cvt_pk_bf16_f32 v72, v128, v129
    s_waitcnt lgkmcnt(6)
    v_mfma_f32_32x32x16_bf16 v[192:207], a[88:91], v[68:71], v[192:207]
    v_add_u32 v255, 0x1c000, v249
    ds_read_b64_tr_b16 a[76:77], v255
    ds_read_b64_tr_b16 a[78:79], v255 offset:2048
    v_cvt_pk_bf16_f32 v73, v130, v131
    v_cvt_pk_bf16_f32 v74, v132, v133
    v_cvt_pk_bf16_f32 v75, v134, v135
    v_mfma_f32_32x32x16_bf16 v[208:223], a[92:95], v[68:71], v[208:223]
    ds_read_b64_tr_b16 a[80:81], v252 offset:4096
    ds_read_b64_tr_b16 a[82:83], v252 offset:6144
    v_mul_f32 v136, v136, v231
    v_mul_f32 v137, v137, v231
    v_mul_f32 v138, v138, v231
    v_mul_f32 v139, v139, v231
    s_waitcnt lgkmcnt(6)
    v_mfma_f32_32x32x16_bf16 v[160:175], a[64:67], v[72:75], v[160:175]
    ds_read_b64_tr_b16 a[84:85], v253 offset:4096
    ds_read_b64_tr_b16 a[86:87], v253 offset:6144
    v_mul_f32 v140, v140, v231
    v_mul_f32 v141, v141, v231
    v_mul_f32 v142, v142, v231
    v_mul_f32 v143, v143, v231
    v_mfma_f32_32x32x16_bf16 v[176:191], a[68:71], v[72:75], v[176:191]
    ds_read_b64_tr_b16 a[88:89], v254 offset:4096
    ds_read_b64_tr_b16 a[90:91], v254 offset:6144
    v_cvt_pk_bf16_f32 v76, v136, v137
    v_cvt_pk_bf16_f32 v77, v138, v139
    v_cvt_pk_bf16_f32 v78, v140, v141
    v_cvt_pk_bf16_f32 v79, v142, v143
    s_waitcnt lgkmcnt(6)
    v_mfma_f32_32x32x16_bf16 v[192:207], a[72:75], v[72:75], v[192:207]
    s_waitcnt vmcnt(20)
    s_barrier
    ds_read_b64_tr_b16 a[92:93], v255 offset:4096
    ds_read_b64_tr_b16 a[94:95], v255 offset:6144
    v_mul_f32 v144, v144, v232
    v_mul_f32 v145, v145, v232
    v_mfma_f32_32x32x16_bf16 v[208:223], a[76:79], v[72:75], v[208:223]
    ds_read_b64_tr_b16 a[64:65], v252 offset:8192
    ds_read_b64_tr_b16 a[66:67], v252 offset:10240
    v_mul_f32 v146, v146, v232
    v_mul_f32 v147, v147, v232
    v_mul_f32 v148, v148, v232
    v_mul_f32 v149, v149, v232
    s_waitcnt lgkmcnt(6)
    v_mfma_f32_32x32x16_bf16 v[160:175], a[80:83], v[76:79], v[160:175]
    ds_read_b64_tr_b16 a[68:69], v252 offset:12288
    ds_read_b64_tr_b16 a[70:71], v252 offset:14336
    v_mul_f32 v150, v150, v232
    v_mul_f32 v151, v151, v232
    v_cvt_pk_bf16_f32 v80, v144, v145
    v_cvt_pk_bf16_f32 v81, v146, v147
    v_mfma_f32_32x32x16_bf16 v[176:191], a[84:87], v[76:79], v[176:191]
    ds_read_b64_tr_b16 a[72:73], v253 offset:8192
    ds_read_b64_tr_b16 a[74:75], v253 offset:10240
    v_cvt_pk_bf16_f32 v82, v148, v149
    v_cvt_pk_bf16_f32 v83, v150, v151
    v_mul_f32 v152, v152, v232
    v_mul_f32 v153, v153, v232
    s_waitcnt lgkmcnt(6)
    v_mfma_f32_32x32x16_bf16 v[192:207], a[88:91], v[76:79], v[192:207]
    ds_read_b64_tr_b16 a[76:77], v253 offset:12288
    ds_read_b64_tr_b16 a[78:79], v253 offset:14336
    v_mul_f32 v154, v154, v232
    v_mul_f32 v155, v155, v232
    v_mul_f32 v156, v156, v232
    v_mul_f32 v157, v157, v232
    v_mfma_f32_32x32x16_bf16 v[208:223], a[92:95], v[76:79], v[208:223]
    ds_read_b64_tr_b16 a[80:81], v254 offset:8192
    ds_read_b64_tr_b16 a[82:83], v254 offset:10240
    v_mul_f32 v158, v158, v232
    v_mul_f32 v159, v159, v232
    v_cvt_pk_bf16_f32 v84, v152, v153
    v_cvt_pk_bf16_f32 v85, v154, v155
    s_waitcnt lgkmcnt(6)
    v_mfma_f32_32x32x16_bf16 v[160:175], a[64:67], v[80:83], v[160:175]
    ds_read_b64_tr_b16 a[84:85], v254 offset:12288
    ds_read_b64_tr_b16 a[86:87], v254 offset:14336
    v_cvt_pk_bf16_f32 v86, v156, v157
    v_cvt_pk_bf16_f32 v87, v158, v159
    s_nop 1
    v_mfma_f32_32x32x16_bf16 v[160:175], a[68:71], v[84:87], v[160:175]
    ds_read_b64_tr_b16 a[88:89], v255 offset:8192
    ds_read_b64_tr_b16 a[90:91], v255 offset:10240
    s_waitcnt lgkmcnt(6)
    v_mfma_f32_32x32x16_bf16 v[176:191], a[72:75], v[80:83], v[176:191]
    ds_read_b64_tr_b16 a[92:93], v255 offset:12288
    ds_read_b64_tr_b16 a[94:95], v255 offset:14336
    v_mfma_f32_32x32x16_bf16 v[176:191], a[76:79], v[84:87], v[176:191]
    v_add_u32 v252, 0x20000, v250
    ds_read_b64_tr_b16 a[64:65], v252
    ds_read_b64_tr_b16 a[66:67], v252 offset:1024
    s_waitcnt lgkmcnt(6)
    v_mfma_f32_32x32x16_bf16 v[192:207], a[80:83], v[80:83], v[192:207]
    v_add_u32 v253, 0x20000, v251
    ds_read_b64_tr_b16 a[68:69], v253
    ds_read_b64_tr_b16 a[70:71], v253 offset:1024
    v_mfma_f32_32x32x16_bf16 v[192:207], a[84:87], v[84:87], v[192:207]
    ds_read_b64_tr_b16 a[72:73], v252 offset:2048
    ds_read_b64_tr_b16 a[74:75], v252 offset:3072
    s_waitcnt lgkmcnt(6)
    v_mfma_f32_32x32x16_bf16 v[208:223], a[88:91], v[80:83], v[208:223]
    ds_read_b64_tr_b16 a[76:77], v253 offset:2048
    ds_read_b64_tr_b16 a[78:79], v253 offset:3072
    v_mfma_f32_32x32x16_bf16 v[208:223], a[92:95], v[84:87], v[208:223]
    ds_read_b64_tr_b16 a[80:81], v252 offset:4096
    ds_read_b64_tr_b16 a[82:83], v252 offset:5120
    s_waitcnt lgkmcnt(6)
    v_mfma_f32_32x32x16_bf16 v[96:111], a[64:67], v[16:19], 0
    ds_read_b64_tr_b16 a[84:85], v253 offset:4096
    ds_read_b64_tr_b16 a[86:87], v253 offset:5120
    v_mfma_f32_32x32x16_bf16 v[112:127], a[68:71], v[16:19], 0
    ds_read_b64_tr_b16 a[88:89], v252 offset:6144
    ds_read_b64_tr_b16 a[90:91], v252 offset:7168
    v_cvt_pk_bf16_f32 v160, v160, v161
    v_cvt_pk_bf16_f32 v161, v162, v163
    v_cvt_pk_bf16_f32 v162, v164, v165
    v_cvt_pk_bf16_f32 v163, v166, v167
    s_waitcnt lgkmcnt(6)
    v_mfma_f32_32x32x16_bf16 v[96:111], a[72:75], v[20:23], v[96:111]
    ds_read_b64_tr_b16 a[92:93], v253 offset:6144
    ds_read_b64_tr_b16 a[94:95], v253 offset:7168
    ds_write_b128 v6, v[160:163]
    v_cvt_pk_bf16_f32 v164, v168, v169
    v_mfma_f32_32x32x16_bf16 v[112:127], a[76:79], v[20:23], v[112:127]
    s_and_b32 s54, s44, 0x1000
    s_add_u32 s54, s54, 0x22000
    v_add_u32 v252, s54, v250
    ds_read_b64_tr_b16 a[64:65], v252
    ds_read_b64_tr_b16 a[66:67], v252 offset:1024
    v_cvt_pk_bf16_f32 v165, v170, v171
    s_waitcnt lgkmcnt(7)
    v_mfma_f32_32x32x16_bf16 v[96:111], a[80:83], v[24:27], v[96:111]
    v_add_u32 v253, s54, v251
    ds_read_b64_tr_b16 a[68:69], v253
    ds_read_b64_tr_b16 a[70:71], v253 offset:1024
    v_cvt_pk_bf16_f32 v166, v172, v173
    v_cvt_pk_bf16_f32 v167, v174, v175
    ds_write_b128 v7, v[164:167]
    v_mfma_f32_32x32x16_bf16 v[112:127], a[84:87], v[24:27], v[112:127]
    ds_read_b64_tr_b16 a[72:73], v252 offset:2048
    ds_read_b64_tr_b16 a[74:75], v252 offset:3072
    v_cvt_pk_bf16_f32 v168, v176, v177
    v_cvt_pk_bf16_f32 v169, v178, v179
    v_cvt_pk_bf16_f32 v170, v180, v181
    v_cvt_pk_bf16_f32 v171, v182, v183
    s_waitcnt lgkmcnt(8)
    v_mfma_f32_32x32x16_bf16 v[96:111], a[88:91], v[28:31], v[96:111]
    s_waitcnt vmcnt(16)
    s_barrier
    ds_read_b64_tr_b16 a[76:77], v253 offset:2048
    ds_read_b64_tr_b16 a[78:79], v253 offset:3072
    ds_write_b128 v8, v[168:171]
    v_mfma_f32_32x32x16_bf16 v[112:127], a[92:95], v[28:31], v[112:127]
    v_add_u32 v252, 0, v250
    ds_read_b64_tr_b16 a[80:81], v252
    ds_read_b64_tr_b16 a[82:83], v252 offset:1024
    v_cvt_pk_bf16_f32 v172, v184, v185
    v_cvt_pk_bf16_f32 v173, v186, v187
    v_cvt_pk_bf16_f32 v174, v188, v189
    s_waitcnt lgkmcnt(8)
    v_mfma_f32_32x32x16_bf16 v[96:111], a[64:67], v[32:35], v[96:111]
    v_add_u32 v253, 0, v251
    ds_read_b64_tr_b16 a[84:85], v253
    ds_read_b64_tr_b16 a[86:87], v253 offset:1024
    v_cvt_pk_bf16_f32 v175, v190, v191
    ds_write_b128 v9, v[172:175]
    v_mfma_f32_32x32x16_bf16 v[112:127], a[68:71], v[32:35], v[112:127]
    ds_read_b64_tr_b16 a[88:89], v252 offset:2048
    ds_read_b64_tr_b16 a[90:91], v252 offset:3072
    ds_read_b128 v[176:179], v10
    ds_read_b128 v[180:183], v10 offset:1024
    s_waitcnt lgkmcnt(14)
    ds_read_b128 v[184:187], v10 offset:2048
    s_waitcnt lgkmcnt(14)
    ds_read_b128 v[188:191], v10 offset:3072
    s_waitcnt lgkmcnt(12)
    v_mfma_f32_32x32x16_bf16 v[96:111], a[72:75], v[36:39], v[96:111]
    ds_read_b64_tr_b16 a[92:93], v253 offset:2048
    ds_read_b64_tr_b16 a[94:95], v253 offset:3072
    s_waitcnt lgkmcnt(5)
    buffer_store_dwordx4 v[176:179], v11, s[16:19], s40 offen nt sc1
    s_waitcnt lgkmcnt(4)
    buffer_store_dwordx4 v[180:183], v11, s[16:19], s41 offen nt sc1
    v_mfma_f32_32x32x16_bf16 v[112:127], a[76:79], v[36:39], v[112:127]
    s_and_b32 s54, s45, 0x1000
    s_add_u32 s54, s54, 0x1000
    v_add_u32 v252, s54, v250
    ds_read_b64_tr_b16 a[64:65], v252
    ds_read_b64_tr_b16 a[66:67], v252 offset:1024
    s_waitcnt lgkmcnt(5)
    buffer_store_dwordx4 v[184:187], v11, s[16:19], s42 offen nt sc1
    v_mfma_f32_32x32x16_bf16 v[96:111], a[80:83], v[40:43], v[96:111]
    v_add_u32 v253, s54, v251
    ds_read_b64_tr_b16 a[68:69], v253
    ds_read_b64_tr_b16 a[70:71], v253 offset:1024
    s_waitcnt lgkmcnt(6)
    buffer_store_dwordx4 v[188:191], v11, s[16:19], s43 offen nt sc1
    v_cvt_pk_bf16_f32 v192, v192, v193
    v_mfma_f32_32x32x16_bf16 v[112:127], a[84:87], v[40:43], v[112:127]
    ds_read_b64_tr_b16 a[72:73], v252 offset:2048
    ds_read_b64_tr_b16 a[74:75], v252 offset:3072
    v_cvt_pk_bf16_f32 v193, v194, v195
    v_cvt_pk_bf16_f32 v194, v196, v197
    v_cvt_pk_bf16_f32 v195, v198, v199
    ds_write_b128 v6, v[192:195]
    v_mfma_f32_32x32x16_bf16 v[96:111], a[88:91], v[44:47], v[96:111]
    ds_read_b64_tr_b16 a[76:77], v253 offset:2048
    ds_read_b64_tr_b16 a[78:79], v253 offset:3072
    v_cvt_pk_bf16_f32 v196, v200, v201
    v_cvt_pk_bf16_f32 v197, v202, v203
    v_cvt_pk_bf16_f32 v198, v204, v205
    v_cvt_pk_bf16_f32 v199, v206, v207
    s_waitcnt lgkmcnt(7)
    v_mfma_f32_32x32x16_bf16 v[112:127], a[92:95], v[44:47], v[112:127]
    v_add_u32 v252, 0x3000, v250
    ds_read_b64_tr_b16 a[80:81], v252
    ds_read_b64_tr_b16 a[82:83], v252 offset:1024
    ds_write_b128 v7, v[196:199]
    v_mfma_f32_32x32x16_bf16 v[96:111], a[64:67], v[48:51], v[96:111]
    v_add_u32 v253, 0x3000, v251
    ds_read_b64_tr_b16 a[84:85], v253
    ds_read_b64_tr_b16 a[86:87], v253 offset:1024
    v_cvt_pk_bf16_f32 v200, v208, v209
    v_cvt_pk_bf16_f32 v201, v210, v211
    v_cvt_pk_bf16_f32 v202, v212, v213
    s_waitcnt lgkmcnt(8)
    v_mfma_f32_32x32x16_bf16 v[112:127], a[68:71], v[48:51], v[112:127]
    ds_read_b64_tr_b16 a[88:89], v252 offset:2048
    ds_read_b64_tr_b16 a[90:91], v252 offset:3072
    v_cvt_pk_bf16_f32 v203, v214, v215
    ds_write_b128 v8, v[200:203]
    v_mfma_f32_32x32x16_bf16 v[96:111], a[72:75], v[52:55], v[96:111]
    s_waitcnt vmcnt(16)
    s_barrier
    ds_read_b64_tr_b16 a[92:93], v253 offset:2048
    ds_read_b64_tr_b16 a[94:95], v253 offset:3072
    v_cvt_pk_bf16_f32 v204, v216, v217
    v_cvt_pk_bf16_f32 v205, v218, v219
    s_waitcnt lgkmcnt(8)
    v_mfma_f32_32x32x16_bf16 v[112:127], a[76:79], v[52:55], v[112:127]
    s_and_b32 s54, s46, 0x1000
    s_add_u32 s54, s54, 0x4000
    v_add_u32 v252, s54, v250
    ds_read_b64_tr_b16 a[64:65], v252
    ds_read_b64_tr_b16 a[66:67], v252 offset:1024
    v_cvt_pk_bf16_f32 v206, v220, v221
    v_mfma_f32_32x32x16_bf16 v[96:111], a[80:83], v[56:59], v[96:111]
    v_add_u32 v253, s54, v251
    ds_read_b64_tr_b16 a[68:69], v253
    ds_read_b64_tr_b16 a[70:71], v253 offset:1024
    v_cvt_pk_bf16_f32 v207, v222, v223
    ds_write_b128 v9, v[204:207]
    s_waitcnt lgkmcnt(8)
    v_mfma_f32_32x32x16_bf16 v[112:127], a[84:87], v[56:59], v[112:127]
    ds_read_b64_tr_b16 a[72:73], v252 offset:2048
    ds_read_b64_tr_b16 a[74:75], v252 offset:3072
    ds_read_b128 v[208:211], v10
    ds_read_b128 v[212:215], v10 offset:1024
    ds_read_b128 v[216:219], v10 offset:2048
    ds_read_b128 v[220:223], v10 offset:3072
    v_mfma_f32_32x32x16_bf16 v[96:111], a[88:91], v[60:63], v[96:111]
    ds_read_b64_tr_b16 a[76:77], v253 offset:2048
    s_waitcnt lgkmcnt(14)
    ds_read_b64_tr_b16 a[78:79], v253 offset:3072
    s_waitcnt lgkmcnt(5)
    buffer_store_dwordx4 v[208:211], v11, s[16:19], s40 offen offset:128 nt sc1
    s_waitcnt lgkmcnt(4)
    buffer_store_dwordx4 v[212:215], v11, s[16:19], s41 offen offset:128 nt sc1
    v_mfma_f32_32x32x16_bf16 v[112:127], a[92:95], v[60:63], v[112:127]
    v_add_u32 v252, 0x6000, v250
    ds_read_b64_tr_b16 a[80:81], v252
    ds_read_b64_tr_b16 a[82:83], v252 offset:1024
    s_waitcnt lgkmcnt(5)
    buffer_store_dwordx4 v[216:219], v11, s[16:19], s42 offen offset:128 nt sc1
    s_waitcnt lgkmcnt(4)
    buffer_store_dwordx4 v[220:223], v11, s[16:19], s43 offen offset:128 nt sc1
    v_mfma_f32_32x32x16_bf16 v[96:111], a[64:67], v[64:67], v[96:111]
    v_add_u32 v253, 0x6000, v251
    ds_read_b64_tr_b16 a[84:85], v253
    ds_read_b64_tr_b16 a[86:87], v253 offset:1024
    v_mfma_f32_32x32x16_bf16 v[112:127], a[68:71], v[64:67], v[112:127]
    ds_read_b64_tr_b16 a[88:89], v252 offset:2048
    ds_read_b64_tr_b16 a[90:91], v252 offset:3072
    v_mfma_f32_32x32x16_bf16 v[96:111], a[72:75], v[68:71], v[96:111]
    ds_read_b64_tr_b16 a[92:93], v253 offset:2048
    ds_read_b64_tr_b16 a[94:95], v253 offset:3072
    s_waitcnt lgkmcnt(6)
    v_mfma_f32_32x32x16_bf16 v[112:127], a[76:79], v[68:71], v[112:127]
    ds_read_b64_tr_b16 a[64:65], v252 offset:4096
    ds_read_b64_tr_b16 a[66:67], v252 offset:5120
    v_mfma_f32_32x32x16_bf16 v[96:111], a[80:83], v[72:75], v[96:111]
    ds_read_b64_tr_b16 a[68:69], v252 offset:6144
    ds_read_b64_tr_b16 a[70:71], v252 offset:7168
    s_waitcnt lgkmcnt(6)
    v_mfma_f32_32x32x16_bf16 v[112:127], a[84:87], v[72:75], v[112:127]
    ds_read_b64_tr_b16 a[72:73], v253 offset:4096
    ds_read_b64_tr_b16 a[74:75], v253 offset:5120
    v_mfma_f32_32x32x16_bf16 v[96:111], a[88:91], v[76:79], v[96:111]
    s_waitcnt vmcnt(16)
    s_barrier
    ds_read_b64_tr_b16 a[76:77], v253 offset:6144
    ds_read_b64_tr_b16 a[78:79], v253 offset:7168
    s_waitcnt lgkmcnt(6)
    v_mfma_f32_32x32x16_bf16 v[112:127], a[92:95], v[76:79], v[112:127]
    ds_read_b64_tr_b16 a[80:81], v252 offset:8192
    ds_read_b64_tr_b16 a[82:83], v252 offset:9216
    v_mfma_f32_32x32x16_bf16 v[96:111], a[64:67], v[80:83], v[96:111]
    ds_read_b64_tr_b16 a[84:85], v253 offset:8192
    ds_read_b64_tr_b16 a[86:87], v253 offset:9216
    s_waitcnt lgkmcnt(6)
    v_mfma_f32_32x32x16_bf16 v[96:111], a[68:71], v[84:87], v[96:111]
    ds_read_b64_tr_b16 a[88:89], v252 offset:10240
    ds_read_b64_tr_b16 a[90:91], v252 offset:11264
    v_mfma_f32_32x32x16_bf16 v[112:127], a[72:75], v[80:83], v[112:127]
    ds_read_b64_tr_b16 a[92:93], v253 offset:10240
    ds_read_b64_tr_b16 a[94:95], v253 offset:11264
    s_waitcnt lgkmcnt(6)
    v_mfma_f32_32x32x16_bf16 v[112:127], a[76:79], v[84:87], v[112:127]
    ds_read_b64_tr_b16 a[64:65], v252 offset:12288
    ds_read_b64_tr_b16 a[66:67], v252 offset:13312
    v_mfma_f32_32x32x16_bf16 v[128:143], a[80:83], v[16:19], 0
    ds_read_b64_tr_b16 a[68:69], v253 offset:12288
    ds_read_b64_tr_b16 a[70:71], v253 offset:13312
    s_waitcnt lgkmcnt(6)
    v_mfma_f32_32x32x16_bf16 v[144:159], a[84:87], v[16:19], 0
    ds_read_b64_tr_b16 a[72:73], v252 offset:14336
    ds_read_b64_tr_b16 a[74:75], v252 offset:15360
    v_cvt_pk_bf16_f32 v96, v96, v97
    v_cvt_pk_bf16_f32 v97, v98, v99
    v_cvt_pk_bf16_f32 v98, v100, v101
    v_cvt_pk_bf16_f32 v99, v102, v103
    v_mfma_f32_32x32x16_bf16 v[128:143], a[88:91], v[20:23], v[128:143]
    ds_read_b64_tr_b16 a[76:77], v253 offset:14336
    ds_read_b64_tr_b16 a[78:79], v253 offset:15360
    ds_write_b128 v6, v[96:99]
    v_cvt_pk_bf16_f32 v100, v104, v105
    s_waitcnt lgkmcnt(7)
    v_mfma_f32_32x32x16_bf16 v[144:159], a[92:95], v[20:23], v[144:159]
    s_and_b32 s54, s44, 0x1000
    s_add_u32 s54, s54, 0xa000
    v_add_u32 v252, s54, v250
    ds_read_b64_tr_b16 a[80:81], v252
    ds_read_b64_tr_b16 a[82:83], v252 offset:1024
    v_cvt_pk_bf16_f32 v101, v106, v107
    v_mfma_f32_32x32x16_bf16 v[128:143], a[64:67], v[24:27], v[128:143]
    v_add_u32 v253, s54, v251
    ds_read_b64_tr_b16 a[84:85], v253
    ds_read_b64_tr_b16 a[86:87], v253 offset:1024
    v_cvt_pk_bf16_f32 v102, v108, v109
    v_cvt_pk_bf16_f32 v103, v110, v111
    ds_write_b128 v7, v[100:103]
    s_waitcnt lgkmcnt(8)
    v_mfma_f32_32x32x16_bf16 v[144:159], a[68:71], v[24:27], v[144:159]
    ds_read_b64_tr_b16 a[88:89], v252 offset:2048
    ds_read_b64_tr_b16 a[90:91], v252 offset:3072
    v_cvt_pk_bf16_f32 v104, v112, v113
    v_cvt_pk_bf16_f32 v105, v114, v115
    v_cvt_pk_bf16_f32 v106, v116, v117
    v_cvt_pk_bf16_f32 v107, v118, v119
    v_mfma_f32_32x32x16_bf16 v[128:143], a[72:75], v[28:31], v[128:143]
    s_waitcnt vmcnt(12)
    s_barrier
    ds_read_b64_tr_b16 a[92:93], v253 offset:2048
    ds_read_b64_tr_b16 a[94:95], v253 offset:3072
    ds_write_b128 v8, v[104:107]
    s_waitcnt lgkmcnt(8)
    v_mfma_f32_32x32x16_bf16 v[144:159], a[76:79], v[28:31], v[144:159]
    v_add_u32 v252, 0xc000, v250
    ds_read_b64_tr_b16 a[64:65], v252
    ds_read_b64_tr_b16 a[66:67], v252 offset:1024
    v_cvt_pk_bf16_f32 v108, v120, v121
    v_cvt_pk_bf16_f32 v109, v122, v123
    v_cvt_pk_bf16_f32 v110, v124, v125
    v_mfma_f32_32x32x16_bf16 v[128:143], a[80:83], v[32:35], v[128:143]
    v_add_u32 v253, 0xc000, v251
    ds_read_b64_tr_b16 a[68:69], v253
    ds_read_b64_tr_b16 a[70:71], v253 offset:1024
    v_cvt_pk_bf16_f32 v111, v126, v127
    ds_write_b128 v9, v[108:111]
    s_waitcnt lgkmcnt(8)
    v_mfma_f32_32x32x16_bf16 v[144:159], a[84:87], v[32:35], v[144:159]
    ds_read_b64_tr_b16 a[72:73], v252 offset:2048
    ds_read_b64_tr_b16 a[74:75], v252 offset:3072
    ds_read_b128 v[112:115], v10
    ds_read_b128 v[116:119], v10 offset:1024
    ds_read_b128 v[120:123], v10 offset:2048
    ds_read_b128 v[124:127], v10 offset:3072
    v_mfma_f32_32x32x16_bf16 v[128:143], a[88:91], v[36:39], v[128:143]
    ds_read_b64_tr_b16 a[76:77], v253 offset:2048
    s_waitcnt lgkmcnt(14)
    ds_read_b64_tr_b16 a[78:79], v253 offset:3072
    s_waitcnt lgkmcnt(5)
    buffer_store_dwordx4 v[112:115], v11, s[16:19], s40 offen offset:256 nt sc1
    s_waitcnt lgkmcnt(4)
    buffer_store_dwordx4 v[116:119], v11, s[16:19], s41 offen offset:256 nt sc1
    v_mfma_f32_32x32x16_bf16 v[144:159], a[92:95], v[36:39], v[144:159]
    s_and_b32 s54, s45, 0x1000
    s_add_u32 s54, s54, 0xd000
    v_add_u32 v252, s54, v250
    ds_read_b64_tr_b16 a[80:81], v252
    ds_read_b64_tr_b16 a[82:83], v252 offset:1024
    s_waitcnt lgkmcnt(5)
    buffer_store_dwordx4 v[120:123], v11, s[16:19], s42 offen offset:256 nt sc1
    v_mfma_f32_32x32x16_bf16 v[128:143], a[64:67], v[40:43], v[128:143]
    v_add_u32 v253, s54, v251
    ds_read_b64_tr_b16 a[84:85], v253
    ds_read_b64_tr_b16 a[86:87], v253 offset:1024
    s_waitcnt lgkmcnt(6)
    buffer_store_dwordx4 v[124:127], v11, s[16:19], s43 offen offset:256 nt sc1
    v_mfma_f32_32x32x16_bf16 v[144:159], a[68:71], v[40:43], v[144:159]
    ds_read_b64_tr_b16 a[88:89], v252 offset:2048
    ds_read_b64_tr_b16 a[90:91], v252 offset:3072
    v_mfma_f32_32x32x16_bf16 v[128:143], a[72:75], v[44:47], v[128:143]
    ds_read_b64_tr_b16 a[92:93], v253 offset:2048
    ds_read_b64_tr_b16 a[94:95], v253 offset:3072
    s_waitcnt lgkmcnt(6)
    v_mfma_f32_32x32x16_bf16 v[144:159], a[76:79], v[44:47], v[144:159]
    v_add_u32 v252, 0xf000, v250
    ds_read_b64_tr_b16 a[64:65], v252
    ds_read_b64_tr_b16 a[66:67], v252 offset:1024
    v_mfma_f32_32x32x16_bf16 v[128:143], a[80:83], v[48:51], v[128:143]
    v_add_u32 v253, 0xf000, v251
    ds_read_b64_tr_b16 a[68:69], v253
    ds_read_b64_tr_b16 a[70:71], v253 offset:1024
    s_waitcnt lgkmcnt(6)
    v_mfma_f32_32x32x16_bf16 v[144:159], a[84:87], v[48:51], v[144:159]
    ds_read_b64_tr_b16 a[72:73], v252 offset:2048
    ds_read_b64_tr_b16 a[74:75], v252 offset:3072
    v_mfma_f32_32x32x16_bf16 v[128:143], a[88:91], v[52:55], v[128:143]
    s_waitcnt vmcnt(12)
    s_barrier
    ds_read_b64_tr_b16 a[76:77], v253 offset:2048
    ds_read_b64_tr_b16 a[78:79], v253 offset:3072
    s_waitcnt lgkmcnt(6)
    v_mfma_f32_32x32x16_bf16 v[144:159], a[92:95], v[52:55], v[144:159]
    s_and_b32 s54, s46, 0x1000
    s_add_u32 s54, s54, 0x10000
    v_add_u32 v252, s54, v250
    ds_read_b64_tr_b16 a[80:81], v252
    ds_read_b64_tr_b16 a[82:83], v252 offset:1024
    v_mfma_f32_32x32x16_bf16 v[128:143], a[64:67], v[56:59], v[128:143]
    v_add_u32 v253, s54, v251
    ds_read_b64_tr_b16 a[84:85], v253
    ds_read_b64_tr_b16 a[86:87], v253 offset:1024
    s_waitcnt lgkmcnt(6)
    v_mfma_f32_32x32x16_bf16 v[144:159], a[68:71], v[56:59], v[144:159]
    ds_read_b64_tr_b16 a[88:89], v252 offset:2048
    ds_read_b64_tr_b16 a[90:91], v252 offset:3072
    v_mfma_f32_32x32x16_bf16 v[128:143], a[72:75], v[60:63], v[128:143]
    ds_read_b64_tr_b16 a[92:93], v253 offset:2048
    ds_read_b64_tr_b16 a[94:95], v253 offset:3072
    s_waitcnt lgkmcnt(6)
    v_mfma_f32_32x32x16_bf16 v[144:159], a[76:79], v[60:63], v[144:159]
    v_add_u32 v252, 0x12000, v250
    ds_read_b64_tr_b16 a[64:65], v252
    ds_read_b64_tr_b16 a[66:67], v252 offset:1024
    v_mfma_f32_32x32x16_bf16 v[128:143], a[80:83], v[64:67], v[128:143]
    v_add_u32 v253, 0x12000, v251
    ds_read_b64_tr_b16 a[68:69], v253
    ds_read_b64_tr_b16 a[70:71], v253 offset:1024
    s_waitcnt lgkmcnt(6)
    v_mfma_f32_32x32x16_bf16 v[144:159], a[84:87], v[64:67], v[144:159]
    ds_read_b64_tr_b16 a[72:73], v252 offset:2048
    ds_read_b64_tr_b16 a[74:75], v252 offset:3072
    v_mfma_f32_32x32x16_bf16 v[128:143], a[88:91], v[68:71], v[128:143]
    ds_read_b64_tr_b16 a[76:77], v253 offset:2048
    ds_read_b64_tr_b16 a[78:79], v253 offset:3072
    s_waitcnt lgkmcnt(6)
    v_mfma_f32_32x32x16_bf16 v[144:159], a[92:95], v[68:71], v[144:159]
    ds_read_b64_tr_b16 a[80:81], v252 offset:4096
    ds_read_b64_tr_b16 a[82:83], v252 offset:5120
    v_mfma_f32_32x32x16_bf16 v[128:143], a[64:67], v[72:75], v[128:143]
    ds_read_b64_tr_b16 a[84:85], v252 offset:6144
    ds_read_b64_tr_b16 a[86:87], v252 offset:7168
    s_waitcnt lgkmcnt(6)
    v_mfma_f32_32x32x16_bf16 v[144:159], a[68:71], v[72:75], v[144:159]
    ds_read_b64_tr_b16 a[88:89], v253 offset:4096
    ds_read_b64_tr_b16 a[90:91], v253 offset:5120
    v_mfma_f32_32x32x16_bf16 v[128:143], a[72:75], v[76:79], v[128:143]
    ds_read_b64_tr_b16 a[92:93], v253 offset:6144
    ds_read_b64_tr_b16 a[94:95], v253 offset:7168
    s_waitcnt lgkmcnt(6)
    v_mfma_f32_32x32x16_bf16 v[144:159], a[76:79], v[76:79], v[144:159]
    v_mfma_f32_32x32x16_bf16 v[128:143], a[80:83], v[80:83], v[128:143]
    s_waitcnt lgkmcnt(2)
    v_mfma_f32_32x32x16_bf16 v[128:143], a[84:87], v[84:87], v[128:143]
    v_mfma_f32_32x32x16_bf16 v[144:159], a[88:91], v[80:83], v[144:159]
    s_waitcnt lgkmcnt(0)
    v_mfma_f32_32x32x16_bf16 v[144:159], a[92:95], v[84:87], v[144:159]
    s_nop 8
    v_cvt_pk_bf16_f32 v128, v128, v129
    v_cvt_pk_bf16_f32 v129, v130, v131
    v_cvt_pk_bf16_f32 v130, v132, v133
    v_cvt_pk_bf16_f32 v131, v134, v135
    ds_write_b128 v6, v[128:131]
    v_cvt_pk_bf16_f32 v132, v136, v137
    v_cvt_pk_bf16_f32 v133, v138, v139
    v_cvt_pk_bf16_f32 v134, v140, v141
    v_cvt_pk_bf16_f32 v135, v142, v143
    ds_write_b128 v7, v[132:135]
    v_cvt_pk_bf16_f32 v136, v144, v145
    v_cvt_pk_bf16_f32 v137, v146, v147
    v_cvt_pk_bf16_f32 v138, v148, v149
    v_cvt_pk_bf16_f32 v139, v150, v151
    ds_write_b128 v8, v[136:139]
    v_cvt_pk_bf16_f32 v140, v152, v153
    v_cvt_pk_bf16_f32 v141, v154, v155
    v_cvt_pk_bf16_f32 v142, v156, v157
    v_cvt_pk_bf16_f32 v143, v158, v159
    ds_write_b128 v9, v[140:143]
    ds_read_b128 v[144:147], v10
    ds_read_b128 v[148:151], v10 offset:1024
    ds_read_b128 v[152:155], v10 offset:2048
    ds_read_b128 v[156:159], v10 offset:3072
    s_waitcnt lgkmcnt(3)
    buffer_store_dwordx4 v[144:147], v11, s[16:19], s40 offen offset:384 nt sc1
    s_waitcnt lgkmcnt(2)
    buffer_store_dwordx4 v[148:151], v11, s[16:19], s41 offen offset:384 nt sc1
    s_waitcnt lgkmcnt(1)
    buffer_store_dwordx4 v[152:155], v11, s[16:19], s42 offen offset:384 nt sc1
    s_waitcnt lgkmcnt(0)
    buffer_store_dwordx4 v[156:159], v11, s[16:19], s43 offen offset:384 nt sc1
L_end:
    s_endpgm
.section .rodata,"a"
.p2align 6
.amdhsa_kernel standalone__sliding_window_attn__prompt_kernel
  .amdhsa_next_free_vgpr 352
  .amdhsa_next_free_sgpr 102
  .amdhsa_accum_offset 256
  .amdhsa_group_segment_fixed_size 0
  .amdhsa_kernarg_size 56
  .amdhsa_user_sgpr_count 2
  .amdhsa_user_sgpr_kernarg_segment_ptr 1
  .amdhsa_system_sgpr_workgroup_id_x 1
.end_amdhsa_kernel
```
